```python
import torch

def _softmax(x, axis=-1):
    return torch.softmax(x, dim=axis)
def _gelu(x):
    return torch.nn.functional.gelu(x, approximate="tanh")
def _silu(x):
    return torch.nn.functional.silu(x)
def _sigmoid(x):
    return torch.sigmoid(x)
def _layernorm(x, axis=-1, eps=1e-5):
    m = x.mean(dim=axis, keepdim=True)
    v = x.var(dim=axis, keepdim=True, unbiased=False)
    return (x - m) / torch.sqrt(v + eps)
def _scatter_add(tgt, idx, src, axis=0):
    return tgt.clone().index_add_(axis, idx, src)
def _segment_sum(src, seg, n):
    out = torch.zeros((n,) + src.shape[1:], dtype=src.dtype)
    return out.index_add_(0, seg, src)
def _pad(x, pw):
    flat = tuple(v for pair in reversed(pw) for v in pair)
    return torch.nn.functional.pad(x, flat)

kernel_name = 'recurrent_scan__mha_block__glu_gated_geglu__prompt'

def setup_inputs():

    _w = (lambda a: (lambda t: t.to(torch.bfloat16) if t.is_floating_point() else t)(torch.as_tensor(a)))
    def _A_setup():
        B, S, D, H = 1, 2048, 512, 32
        return {
            "x": _w((lambda *s: torch.randn(*s, dtype=torch.bfloat16) * 0.05)(B, S, D)),
            "wqkv": _w((lambda *s: torch.randn(*s, dtype=torch.bfloat16) * 0.2)(D, 3 * D)),
            "wo": _w((lambda *s: torch.randn(*s, dtype=torch.bfloat16) * 0.2)(D, D)),
        }
    _A_in = _A_setup()

    def _B_setup():
        B, S, Dm, Df = 1, 2048, 512, 1792
        return {
            "x": _w((lambda *s: torch.randn(*s, dtype=torch.bfloat16) * 0.05)(B, S, Dm)),
            "w_gate": _w((lambda *s: torch.randn(*s, dtype=torch.bfloat16) * 0.1)(Dm, Df) * (Dm ** -0.5)),
            "w_up": _w((lambda *s: torch.randn(*s, dtype=torch.bfloat16) * 0.1)(Dm, Df) * (Dm ** -0.5)),
            "w_down": _w((lambda *s: torch.randn(*s, dtype=torch.bfloat16) * 0.1)(Df, Dm) * (Df ** -0.5)),
        }
    _B_in = _B_setup()

    return {
        "A_x": _A_in["x"],
        "A_wqkv": _A_in["wqkv"],
        "A_wo": _A_in["wo"],
        "B_x": _B_in["x"],
        "B_w_gate": _B_in["w_gate"],
        "B_w_up": _B_in["w_up"],
        "B_w_down": _B_in["w_down"],
    }

def reference(A_x, A_wqkv, A_wo, B_x, B_w_gate, B_w_up, B_w_down):
    def _A_ref(x, wqkv, wo):
        B, S, D = x.shape
        H = 32
        Dh = D // H
        qkv = (lambda x, *d: x.permute(*d))((x @ wqkv).reshape(B, S, 3, H, Dh), 2, 0, 3, 1, 4)
        q, k, v = qkv[0], qkv[1], qkv[2]
        scores = torch.einsum("bhqd,bhkd->bhqk", q, k) * (Dh ** -0.5)
        p = _softmax(scores, axis=-1)
        o = torch.einsum("bhqk,bhkd->bhqd", p, v)
        return (lambda x, *d: x.permute(*d))(o, 0, 2, 1, 3).reshape(B, S, D) @ wo

    def _B_ref(x, w_gate, w_up, w_down):
        g = torch.einsum("bsd,df->bsf", x, w_gate)
        u = torch.einsum("bsd,df->bsf", x, w_up)
        h = _gelu(g) * u
        return torch.einsum("bsf,fd->bsd", h, w_down)

    x = A_x
    xn = _layernorm(x, axis=-1)
    s = _A_ref(xn, A_wqkv, A_wo)
    g = _silu(_B_ref(xn, B_w_gate, B_w_up, B_w_down))
    return x + s * g
```

```asm
; @launch grid=(256,1,1) block=(512,1,1) lds=163392
.amdgcn_target "amdgcn-amd-amdhsa--gfx950"
.text
.globl recurrent_scan__mha_block__glu_gated_geglu__prompt_kernel
.p2align 8
.type recurrent_scan__mha_block__glu_gated_geglu__prompt_kernel,@function
recurrent_scan__mha_block__glu_gated_geglu__prompt_kernel:
    s_cmp_ge_u32 s2, 256
    s_cbranch_scc1 L_end
    v_lshrrev_b32 v1, 6, v0
    s_getpc_b64 s[4:5]
L_pc:
    v_readfirstlane_b32 s42, v1
    s_and_b32 s47, s2, 0xf8
    s_load_dwordx2 s[16:17], s[0:1], 0
    s_add_u32 s47, s47, s42
    s_lshl_b32 s47, s47, 6
    s_load_dword s6, s[4:5], s47
    s_add_u32 s47, s47, 0x4000
    s_min_u32 s47, s47, L_code_end-L_pc-4
    s_load_dword s7, s[4:5], s47
    s_load_dwordx2 s[20:21], s[0:1], 8
    s_load_dwordx2 s[24:25], s[0:1], 32
    s_load_dwordx2 s[28:29], s[0:1], 40
    s_load_dwordx2 s[32:33], s[0:1], 72
    v_and_b32 v0, 63, v0
    s_and_b32 s3, s2, 7
    s_lshr_b32 s43, s2, 3
    s_lshr_b32 s40, s3, 2
    s_lshl_b32 s40, s40, 3
    s_and_b32 s70, s43, 7
    s_add_u32 s40, s40, s70
    s_and_b32 s41, s3, 3
    s_lshl_b32 s41, s41, 2
    s_lshr_b32 s71, s43, 3
    s_add_u32 s41, s41, s71
    s_and_b32 s44, s42, 3
    s_lshr_b32 s45, s44, 1
    s_and_b32 s46, s44, 1
    s_mov_b32 s34, 0x1500000
    s_mov_b32 s35, 0x20000
    s_mov_b32 s18, 2097152
    s_mov_b32 s19, 0x20000
    s_mov_b32 s22, 1572864
    s_mov_b32 s23, 0x20000
    s_lshl_b32 s74, s3, 2
    s_add_u32 s74, s74, s71
    s_mov_b32 s75, s70
    s_and_b32 s47, s42, 6
    s_cmp_eq_u32 s47, 4
    s_cbranch_scc1 L_L
    s_cmp_lt_u32 s42, 4
    s_cbranch_scc1 L_C
    s_branch L_M
L_L:
    v_lshrrev_b32 v112, 3, v0
    v_and_b32 v113, 7, v0
    v_lshlrev_b32 v113, 4, v113
    v_and_b32 v117, 4, v112
    v_bfe_u32 v118, v112, 1, 1
    v_and_b32 v119, 1, v112
    v_lshl_add_u32 v118, v119, 1, v118
    v_add_u32 v117, v117, v118
    v_lshl_add_u32 v117, v117, 14, v113
    s_lshl_b32 s47, s40, 17
    s_lshl_b32 s61, s46, 12
    s_add_u32 s47, s47, s61
    v_add_u32 v117, s47, v117
    s_lshl_b32 s62, s71, 1
    s_add_u32 s59, s70, s62
    s_and_b32 s47, s3, 1
    s_add_u32 s59, s59, s47
    s_and_b32 s59, s59, 7
    s_lshl_b32 s55, s59, 7
    s_lshl_b32 s59, s59, 1
    s_mul_i32 s58, s46, 4160
    s_add_u32 s58, s58, 76800
    s_mov_b32 s54, s58
    s_mov_b32 s57, 0
    s_and_b32 s64, s3, 3
    s_mul_i32 s65, s64, 7
    s_add_u32 s65, s65, s62
    s_lshl_b32 s65, s65, 7
    s_add_u32 s66, s65, 128
    s_lshl_b32 s64, s64, 8
    s_add_u32 s64, s64, 2048
    s_cmp_lt_u32 s71, 3
    s_mov_b32 s38, 1572864
    s_cmov_b32 s38, 1835008
    s_mov_b32 s14, 1572736
    s_cmov_b32 s14, 1835008
    s_mov_b32 s39, 0x20000
    s_mov_b32 s15, 0x20000
    s_movk_i32 s48, 3072
    s_cmovk_i32 s48, 3584
    s_cselect_b32 s64, s65, s64
    s_cselect_b32 s65, s66, s65
    s_lshl_b32 s47, s46, 1
    v_lshl_add_u32 v114, v112, 2, s47
    v_mul_u32_u24 v115, 3072, v114
    s_lshl_b32 s47, s41, 7
    v_add3_u32 v115, v115, v113, s47
    v_mul_lo_u32 v122, v114, s48
    v_add3_u32 v122, v122, v113, s64
    v_add_u32 v123, s48, v122
    s_lshl_b32 s48, s48, 5
    s_mul_i32 s50, s59, 98304
    s_mul_i32 s49, s59, s48
    s_mul_i32 s52, s46, 2112
    s_add_u32 s52, s52, 25600
    s_lshl_b32 s69, s46, 6
    s_mov_b32 s60, 0
    s_waitcnt lgkmcnt(0)
    s_call_b64 s[8:9], LL_X
    s_add_u32 s62, s20, 128
    s_addc_u32 s63, s21, 0
    s_cmp_lt_u32 s71, 3
    s_cselect_b64 s[36:37], s[24:25], s[20:21]
    s_cselect_b64 s[12:13], s[28:29], s[62:63]
    s_call_b64 s[8:9], LL_X
    s_call_b64 s[8:9], LL_A
    s_call_b64 s[8:9], LL_A
    s_branch LL_go
LL_X:
    s_add_u32 m0, s54, 0
    s_add_u32 s57, s57, 1
    buffer_load_dwordx4 v117, s[16:19], s55 offen offset:0  lds
    s_add_u32 m0, s54, 16
    s_lshr_b32 s67, s57, 1
    buffer_load_dwordx4 v117, s[16:19], s55 offen offset:1024  lds
    s_add_u32 m0, s54, 32
    s_sub_u32 s68, 11, s67
    buffer_load_dwordx4 v117, s[16:19], s55 offen offset:2048  lds
    s_add_u32 m0, s54, 48
    s_cmp_lt_u32 s57, 16
    s_cselect_b32 s67, s67, s68
    buffer_load_dwordx4 v117, s[16:19], s55 offen offset:3072  lds
    s_and_b32 s68, s67, 3
    s_lshl_b32 s68, s68, 1
    s_and_b32 s62, s57, 1
    s_add_u32 s68, s68, s62
    s_mul_i32 s68, s68, 8320
    s_add_u32 s54, s68, s58
    s_lshl_b32 s67, s67, 1
    s_add_u32 s67, s67, s59
    s_and_b32 s67, s67, 15
    s_lshl_b32 s67, s67, 6
    s_lshl_b32 s62, s62, 13
    s_add_u32 s55, s67, s62
    s_setpc_b64 s[8:9]
LL_A:
    s_add_u32 m0, s52, 0
    s_add_u32 s60, s60, 1
    buffer_load_dwordx4 v122, s[36:39], s49 offen  lds
    s_add_u32 m0, s52, 1056
    s_add_u32 s47, s60, s59
    buffer_load_dwordx4 v123, s[36:39], s49 offen  lds
    s_add_u32 m0, s52, 4224
    s_and_b32 s47, s47, 15
    buffer_load_dwordx4 v122, s[12:15], s49 offen  lds
    s_add_u32 m0, s52, 5280
    s_add_u32 s61, s52, s69
    buffer_load_dwordx4 v123, s[12:15], s49 offen  lds
    s_add_u32 m0, s61, 8448
    s_mul_i32 s49, s47, s48
    s_add_u32 s52, s52, 12800
    buffer_load_dwordx4 v115, s[20:23], s50 offen offset:0  lds
    s_add_u32 m0, s61, 6464
    s_cmp_ge_u32 s52, 51200
    s_cselect_b32 s63, 51200, 0
    s_sub_u32 s52, s52, s63
    buffer_load_dwordx4 v115, s[20:23], s50 offen offset:3072  lds
    s_mul_i32 s50, s47, 98304
    s_setpc_b64 s[8:9]
LL_go:
    s_mov_b32 s26, 1835008
    s_mov_b32 s30, 1835008
    s_mov_b32 s27, 0x20000
    s_mov_b32 s31, 0x20000
    v_mul_u32_u24 v120, 3584, v114
    v_add3_u32 v120, v120, v113, s65
    v_add_u32 v121, 3584, v120
    s_mul_i32 s51, s59, 114688
    s_mul_i32 s53, s46, 2112
    s_add_u32 s53, s53, 51200
    s_mov_b32 s56, 0
    s_call_b64 s[8:9], LH_prep
    s_waitcnt vmcnt(6)
    s_barrier
    s_call_b64 s[8:9], LL_B
    s_add_u32 s47, s59, 1
    s_mul_i32 s51, s47, 114688
    s_call_b64 s[8:9], LL_B
    s_add_u32 s47, s59, 14
    s_and_b32 s47, s47, 15
    s_mul_i32 s51, s47, 114688
    s_add_u32 s53, s53, 25600
    s_mov_b32 s56, 0
    s_call_b64 s[8:9], LL_X
    s_call_b64 s[8:9], LL_X
    s_waitcnt vmcnt(16)
    s_barrier
    s_call_b64 s[8:9], LL_A
    s_waitcnt vmcnt(14)
    s_barrier
    s_call_b64 s[8:9], LL_A
    s_call_b64 s[8:9], LL_X
    s_call_b64 s[8:9], LL_X
    s_call_b64 s[8:9], LL_A
    s_waitcnt vmcnt(20)
LL_loopA:
    s_barrier
    s_add_u32 m0, s54, 0
    s_add_u32 s57, s57, 1
    buffer_load_dwordx4 v117, s[16:19], s55 offen offset:0  lds
    s_add_u32 m0, s54, 16
    s_lshr_b32 s67, s57, 1
    buffer_load_dwordx4 v117, s[16:19], s55 offen offset:1024  lds
    s_add_u32 m0, s54, 32
    s_sub_u32 s68, 11, s67
    buffer_load_dwordx4 v117, s[16:19], s55 offen offset:2048  lds
    s_add_u32 m0, s54, 48
    s_cmp_lt_u32 s57, 16
    s_cselect_b32 s67, s67, s68
    buffer_load_dwordx4 v117, s[16:19], s55 offen offset:3072  lds
    s_add_u32 m0, s52, 0
    s_add_u32 s60, s60, 1
    s_and_b32 s68, s67, 3
    s_lshl_b32 s68, s68, 1
    buffer_load_dwordx4 v122, s[36:39], s49 offen  lds
    s_add_u32 m0, s52, 1056
    s_add_u32 s47, s60, s59
    s_and_b32 s62, s57, 1
    s_add_u32 s68, s68, s62
    buffer_load_dwordx4 v123, s[36:39], s49 offen  lds
    s_add_u32 m0, s52, 4224
    s_and_b32 s47, s47, 15
    s_mul_i32 s68, s68, 8320
    s_add_u32 s54, s68, s58
    s_lshl_b32 s67, s67, 1
    buffer_load_dwordx4 v122, s[12:15], s49 offen  lds
    s_add_u32 m0, s52, 5280
    s_add_u32 s61, s52, s69
    s_add_u32 s67, s67, s59
    s_and_b32 s67, s67, 15
    s_lshl_b32 s67, s67, 6
    s_lshl_b32 s62, s62, 13
    s_add_u32 s55, s67, s62
    buffer_load_dwordx4 v123, s[12:15], s49 offen  lds
    s_add_u32 m0, s61, 8448
    s_mul_i32 s49, s47, s48
    s_add_u32 s52, s52, 12800
    buffer_load_dwordx4 v115, s[20:23], s50 offen offset:0  lds
    s_add_u32 m0, s61, 6464
    s_cmp_ge_u32 s52, 51200
    s_cselect_b32 s63, 51200, 0
    s_sub_u32 s52, s52, s63
    buffer_load_dwordx4 v115, s[20:23], s50 offen offset:3072  lds
    s_mul_i32 s50, s47, 98304
    s_cmp_lt_u32 s60, 15
    s_waitcnt vmcnt(20)
    s_cbranch_scc1 LL_loopA
    s_waitcnt vmcnt(20)
    s_barrier
    s_call_b64 s[8:9], LL_A
    s_call_b64 s[8:9], LL_B
    s_waitcnt vmcnt(20)
    s_barrier
    s_call_b64 s[8:9], LL_B
    s_call_b64 s[8:9], LL_B
    s_waitcnt vmcnt(18)
    s_barrier
    s_call_b64 s[8:9], LL_B
    s_waitcnt vmcnt(16)
    s_barrier
    s_call_b64 s[8:9], LL_B
    s_waitcnt vmcnt(16)
    s_barrier
    s_call_b64 s[8:9], LL_B
    s_waitcnt vmcnt(16)
    s_barrier
    s_call_b64 s[8:9], LL_B
    s_waitcnt vmcnt(16)
    s_barrier
    s_call_b64 s[8:9], LL_X
    s_waitcnt vmcnt(16)
    s_barrier
    s_call_b64 s[8:9], LL_B
    s_waitcnt vmcnt(16)
LL_loopB:
    s_barrier
    s_add_u32 m0, s54, 0
    s_add_u32 s57, s57, 1
    buffer_load_dwordx4 v117, s[16:19], s55 offen offset:0  lds
    s_add_u32 m0, s54, 16
    s_lshr_b32 s67, s57, 1
    buffer_load_dwordx4 v117, s[16:19], s55 offen offset:1024  lds
    s_add_u32 m0, s54, 32
    s_sub_u32 s68, 11, s67
    buffer_load_dwordx4 v117, s[16:19], s55 offen offset:2048  lds
    s_add_u32 m0, s54, 48
    s_cmp_lt_u32 s57, 16
    s_cselect_b32 s67, s67, s68
    buffer_load_dwordx4 v117, s[16:19], s55 offen offset:3072  lds
    s_add_u32 m0, s53, 0
    s_add_u32 s56, s56, 1
    s_and_b32 s68, s67, 3
    s_lshl_b32 s68, s68, 1
    buffer_load_dwordx4 v120, s[24:27], s51 offen  lds
    s_add_u32 m0, s53, 1056
    s_xor_b32 s47, s56, 14
    s_and_b32 s62, s57, 1
    s_add_u32 s68, s68, s62
    buffer_load_dwordx4 v121, s[24:27], s51 offen  lds
    s_add_u32 m0, s53, 4224
    s_add_u32 s47, s47, s59
    s_and_b32 s47, s47, 15
    s_mul_i32 s68, s68, 8320
    s_add_u32 s54, s68, s58
    s_lshl_b32 s67, s67, 1
    buffer_load_dwordx4 v120, s[28:31], s51 offen  lds
    s_add_u32 m0, s53, 5280
    s_bitcmp1_b32 s56, 0
    s_mov_b32 s63, 38400
    s_cmov_b32 s63, 12800
    s_add_u32 s53, s53, s63
    s_cmp_ge_u32 s53, 76800
    s_cselect_b32 s63, 76800, 0
    s_sub_u32 s53, s53, s63
    s_add_u32 s67, s67, s59
    s_and_b32 s67, s67, 15
    s_lshl_b32 s67, s67, 6
    s_lshl_b32 s62, s62, 13
    s_add_u32 s55, s67, s62
    buffer_load_dwordx4 v121, s[28:31], s51 offen  lds
    s_mul_i32 s51, s47, 114688
    s_cmp_lt_u32 s56, 13
    s_waitcnt vmcnt(20)
    s_cbranch_scc1 LL_loopB
    s_waitcnt vmcnt(24)
    s_barrier
    s_call_b64 s[8:9], LL_B
    s_waitcnt vmcnt(20)
    s_barrier
    v_mov_b32 v113, 163332
    ds_read_b32 v3, v113
    s_mov_b32 s52, 0x13c0000
    s_lshl_b32 s61, s74, 3
    s_add_u32 s61, s61, s75
    s_lshl_b32 s61, s61, 13
    s_lshl_b32 s47, s46, 12
    s_add_u32 s61, s61, s47
    s_lshl_b32 s62, s46, 13
    s_add_u32 s62, s62, 131584
    s_lshl_b32 s63, s46, 10
    s_lshl_b32 s47, s74, 17
    s_add_u32 s47, s47, 0x200000
    s_add_u32 s47, s47, s63
    s_mov_b32 s53, 0
    s_waitcnt vmcnt(12)
    s_barrier
    s_waitcnt vmcnt(4)
    s_barrier
    s_waitcnt vmcnt(0)
    s_barrier
    buffer_load_dword v241, v251, s[32:35], s52 offen sc1
    s_setprio 2
    s_barrier
LL_f1:
    s_add_u32 s53, s53, 1
    s_waitcnt vmcnt(0) lgkmcnt(0)
    v_cmp_ne_u32 vcc, v3, v241
    s_cbranch_vccz LL_f1ok
    s_sleep 4
    buffer_load_dword v241, v251, s[32:35], s52 offen sc1
    s_cmp_lt_u32 s53, 262144
    s_cbranch_scc1 LL_f1
LL_f1ok:
    s_call_b64 s[8:9], LL_qkv
    s_branch LH_join
LL_qkv:
    s_add_u32 m0, s62, 0
    s_nop 0
    buffer_load_dwordx4 v1, s[32:35], s61 offen offset:0 sc1 lds
    s_add_u32 m0, s62, 1024
    s_nop 0
    buffer_load_dwordx4 v1, s[32:35], s61 offen offset:1024 sc1 lds
    s_add_u32 m0, s62, 2048
    s_nop 0
    buffer_load_dwordx4 v1, s[32:35], s61 offen offset:2048 sc1 lds
    s_add_u32 m0, s62, 3072
    s_nop 0
    buffer_load_dwordx4 v1, s[32:35], s61 offen offset:3072 sc1 lds
    s_mov_b32 m0, s63
    s_nop 0
LL_kv:
    buffer_load_dwordx4 v1, s[32:35], s47 offen sc1 lds
    buffer_load_dwordx4 v1, s[32:35], s47 offen offset:2048 sc1 lds
    s_add_u32 m0, m0, 4096
    s_add_u32 s47, s47, 4096
    s_cmp_lt_u32 m0, 20480
    s_cbranch_scc1 LL_kv
    s_setpc_b64 s[8:9]
LL_B:
    s_add_u32 m0, s53, 0
    s_add_u32 s56, s56, 1
    buffer_load_dwordx4 v120, s[24:27], s51 offen  lds
    s_add_u32 m0, s53, 1056
    s_xor_b32 s47, s56, 14
    buffer_load_dwordx4 v121, s[24:27], s51 offen  lds
    s_add_u32 m0, s53, 4224
    s_add_u32 s47, s47, s59
    s_and_b32 s47, s47, 15
    buffer_load_dwordx4 v120, s[28:31], s51 offen  lds
    s_add_u32 m0, s53, 5280
    s_bitcmp1_b32 s56, 0
    s_mov_b32 s63, 38400
    s_cmov_b32 s63, 12800
    s_add_u32 s53, s53, s63
    s_cmp_ge_u32 s53, 76800
    s_cselect_b32 s63, 76800, 0
    s_sub_u32 s53, s53, s63
    buffer_load_dwordx4 v121, s[28:31], s51 offen  lds
    s_mul_i32 s51, s47, 114688
    s_setpc_b64 s[8:9]
L_M:
    s_setprio 3
    s_mov_b32 s45, s46
    v_bfe_u32 v5, v0, 4, 1
    v_bfe_u32 v6, v0, 2, 2
    v_lshrrev_b32 v7, 5, v0
    v_and_b32 v1, 3, v0
    v_lshlrev_b32 v1, 3, v1
    v_lshl_add_u32 v1, v7, 8, v1
    v_mul_u32_u24 v2, 4224, v5
    v_mul_u32_u24 v112, 1056, v6
    v_add3_u32 v2, v2, v112, v1
    v_mul_u32_u24 v112, 1088, v6
    v_lshl_add_u32 v3, v5, 5, v112
    v_add_u32 v3, v3, v1
    v_and_b32 v112, 15, v0
    v_mul_u32_u24 v112, 1040, v112
    v_lshl_add_u32 v4, v5, 8, v112
    v_lshl_add_u32 v4, v7, 4, v4
    s_lshl_b32 s47, s45, 6
    v_add_u32 v2, s47, v2
    s_add_u32 s47, s47, 8448
    v_add_u32 v3, s47, v3
    s_mov_b32 s45, 1
    s_mov_b32 s73, 0x3f803f80
    s_lshl_b32 s47, s46, 9
    s_add_u32 s47, s47, 76800
    v_add_u32 v4, s47, v4
    v_lshlrev_b32 v1, 4, v0
    s_mov_b32 s50, 0
    v_mov_b64 v[120:121], 0
    v_mov_b64 v[122:123], 0
    v_mov_b64 v[124:125], 0
    v_mov_b64 v[126:127], 0
    v_mov_b64 v[128:129], 0
    v_mov_b64 v[130:131], 0
    s_mov_b32 s47, 0x13d0000
    s_waitcnt lgkmcnt(0)
    buffer_load_dword v134, off, s[32:35], s47 sc1
    s_call_b64 s[8:9], LH_prep
    v_add_u32 v114, 51200, v2
    v_add_u32 v2, 25600, v2
    v_add_u32 v3, 25600, v3
LM_stat:
    s_bitcmp1_b32 s50, 0
    s_cbranch_scc1 LM_nobar
    s_barrier
LM_nobar:
    ds_read_b128 v[148:151], v4
    ds_read_b128 v[152:155], v4 offset:128
    ds_read_b64_tr_b16 v[136:137], v3
    ds_read_b64_tr_b16 v[138:139], v3 offset:128
    ds_read_b64_tr_b16 v[140:141], v2 offset:0
    ds_read_b64_tr_b16 v[142:143], v2 offset:128
    ds_read_b64_tr_b16 v[144:145], v2 offset:32
    ds_read_b64_tr_b16 v[146:147], v2 offset:160
    s_movk_i32 s47, 512
    s_cmovk_i32 s47, 12288
    v_add_u32 v2, s47, v2
    v_add_u32 v3, s47, v3
    v_add_u32 v4, 32, v4
    s_add_u32 s50, s50, 1
    s_waitcnt lgkmcnt(6)
    v_dot2c_f32_bf16 v128, s73, v148
    v_dot2c_f32_bf16 v129, v148, v148
    v_dot2c_f32_bf16 v130, s73, v152
    v_dot2c_f32_bf16 v131, v152, v152
    v_dot2c_f32_bf16 v128, s73, v149
    v_dot2c_f32_bf16 v129, v149, v149
    v_dot2c_f32_bf16 v130, s73, v153
    v_dot2c_f32_bf16 v131, v153, v153
    v_dot2c_f32_bf16 v128, s73, v150
    v_dot2c_f32_bf16 v129, v150, v150
    v_dot2c_f32_bf16 v130, s73, v154
    v_dot2c_f32_bf16 v131, v154, v154
    v_dot2c_f32_bf16 v128, s73, v151
    v_dot2c_f32_bf16 v129, v151, v151
    v_dot2c_f32_bf16 v130, s73, v155
    v_dot2c_f32_bf16 v131, v155, v155
    s_waitcnt lgkmcnt(0)
    v_dot2c_f32_bf16 v120, s73, v136
    v_dot2c_f32_bf16 v121, s73, v140
    v_dot2c_f32_bf16 v122, s73, v144
    v_dot2c_f32_bf16 v120, s73, v137
    v_dot2c_f32_bf16 v121, s73, v141
    v_dot2c_f32_bf16 v122, s73, v145
    v_dot2c_f32_bf16 v120, s73, v138
    v_dot2c_f32_bf16 v121, s73, v142
    v_dot2c_f32_bf16 v122, s73, v146
    v_dot2c_f32_bf16 v120, s73, v139
    v_dot2c_f32_bf16 v121, s73, v143
    v_dot2c_f32_bf16 v122, s73, v147
    s_cmp_lt_u32 s50, 4
    s_cbranch_scc1 LM_stat
    s_barrier
    ds_read_b64_tr_b16 v[136:137], v114 offset:0
    ds_read_b64_tr_b16 v[138:139], v114 offset:128
    ds_read_b64_tr_b16 v[140:141], v114 offset:32
    ds_read_b64_tr_b16 v[142:143], v114 offset:160
    ds_read_b64_tr_b16 v[144:145], v114 offset:512
    ds_read_b64_tr_b16 v[146:147], v114 offset:640
    ds_read_b64_tr_b16 v[148:149], v114 offset:544
    ds_read_b64_tr_b16 v[150:151], v114 offset:672
    ds_read_b64_tr_b16 v[152:153], v114 offset:12800
    ds_read_b64_tr_b16 v[154:155], v114 offset:12928
    ds_read_b64_tr_b16 v[156:157], v114 offset:12832
    ds_read_b64_tr_b16 v[158:159], v114 offset:12960
    s_waitcnt lgkmcnt(4)
    ds_read_b64_tr_b16 v[160:161], v114 offset:13312
    ds_read_b64_tr_b16 v[162:163], v114 offset:13440
    ds_read_b64_tr_b16 v[164:165], v114 offset:13344
    ds_read_b64_tr_b16 v[166:167], v114 offset:13472
    s_lshl_b32 s50, s41, 4
    s_add_u32 s50, s50, s40
    s_lshl_b32 s50, s50, 1
    s_add_u32 s50, s50, s46
    s_lshl_b32 s50, s50, 10
    s_add_u32 s50, s50, 0x1200000
    s_lshl_b32 s51, s40, 4
    s_add_u32 s51, s51, s41
    s_lshl_b32 s51, s51, 1
    s_add_u32 s51, s51, s46
    s_lshl_b32 s51, s51, 10
    s_add_u32 s51, s51, 0x1280000
    s_waitcnt lgkmcnt(0)
    v_lshlrev_b32 v132, 16, v136
    v_and_b32 v133, 0xffff0000, v136
    v_add_f32 v123, v123, v132
    v_add_f32 v125, v125, v133
    v_lshlrev_b32 v132, 16, v140
    v_and_b32 v133, 0xffff0000, v140
    v_add_f32 v124, v124, v132
    v_add_f32 v126, v126, v133
    v_lshlrev_b32 v132, 16, v137
    v_and_b32 v133, 0xffff0000, v137
    v_add_f32 v123, v123, v132
    v_add_f32 v125, v125, v133
    v_lshlrev_b32 v132, 16, v141
    v_and_b32 v133, 0xffff0000, v141
    v_add_f32 v124, v124, v132
    v_add_f32 v126, v126, v133
    v_lshlrev_b32 v132, 16, v138
    v_and_b32 v133, 0xffff0000, v138
    v_add_f32 v123, v123, v132
    v_add_f32 v125, v125, v133
    v_lshlrev_b32 v132, 16, v142
    v_and_b32 v133, 0xffff0000, v142
    v_add_f32 v124, v124, v132
    v_add_f32 v126, v126, v133
    v_lshlrev_b32 v132, 16, v139
    v_and_b32 v133, 0xffff0000, v139
    v_add_f32 v123, v123, v132
    v_add_f32 v125, v125, v133
    v_lshlrev_b32 v132, 16, v143
    v_and_b32 v133, 0xffff0000, v143
    v_add_f32 v124, v124, v132
    v_add_f32 v126, v126, v133
    v_lshlrev_b32 v132, 16, v144
    v_and_b32 v133, 0xffff0000, v144
    v_add_f32 v123, v123, v132
    v_add_f32 v125, v125, v133
    v_lshlrev_b32 v132, 16, v148
    v_and_b32 v133, 0xffff0000, v148
    v_add_f32 v124, v124, v132
    v_add_f32 v126, v126, v133
    v_lshlrev_b32 v132, 16, v145
    v_and_b32 v133, 0xffff0000, v145
    v_add_f32 v123, v123, v132
    v_add_f32 v125, v125, v133
    v_lshlrev_b32 v132, 16, v149
    v_and_b32 v133, 0xffff0000, v149
    v_add_f32 v124, v124, v132
    v_add_f32 v126, v126, v133
    v_lshlrev_b32 v132, 16, v146
    v_and_b32 v133, 0xffff0000, v146
    v_add_f32 v123, v123, v132
    v_add_f32 v125, v125, v133
    v_lshlrev_b32 v132, 16, v150
    v_and_b32 v133, 0xffff0000, v150
    v_add_f32 v124, v124, v132
    v_add_f32 v126, v126, v133
    v_lshlrev_b32 v132, 16, v147
    v_and_b32 v133, 0xffff0000, v147
    v_add_f32 v123, v123, v132
    v_add_f32 v125, v125, v133
    v_lshlrev_b32 v132, 16, v151
    v_and_b32 v133, 0xffff0000, v151
    v_add_f32 v124, v124, v132
    v_add_f32 v126, v126, v133
    s_barrier
    v_lshlrev_b32 v132, 16, v152
    v_and_b32 v133, 0xffff0000, v152
    v_add_f32 v123, v123, v132
    v_add_f32 v125, v125, v133
    v_lshlrev_b32 v132, 16, v156
    v_and_b32 v133, 0xffff0000, v156
    v_add_f32 v124, v124, v132
    v_add_f32 v126, v126, v133
    v_lshlrev_b32 v132, 16, v153
    v_and_b32 v133, 0xffff0000, v153
    v_add_f32 v123, v123, v132
    v_add_f32 v125, v125, v133
    v_lshlrev_b32 v132, 16, v157
    v_and_b32 v133, 0xffff0000, v157
    v_add_f32 v124, v124, v132
    v_add_f32 v126, v126, v133
    v_lshlrev_b32 v132, 16, v154
    v_and_b32 v133, 0xffff0000, v154
    v_add_f32 v123, v123, v132
    v_add_f32 v125, v125, v133
    v_lshlrev_b32 v132, 16, v158
    v_and_b32 v133, 0xffff0000, v158
    v_add_f32 v124, v124, v132
    v_add_f32 v126, v126, v133
    v_lshlrev_b32 v132, 16, v155
    v_and_b32 v133, 0xffff0000, v155
    v_add_f32 v123, v123, v132
    v_add_f32 v125, v125, v133
    v_lshlrev_b32 v132, 16, v159
    v_and_b32 v133, 0xffff0000, v159
    v_add_f32 v124, v124, v132
    v_add_f32 v126, v126, v133
    v_lshlrev_b32 v132, 16, v160
    v_and_b32 v133, 0xffff0000, v160
    v_add_f32 v123, v123, v132
    v_add_f32 v125, v125, v133
    v_lshlrev_b32 v132, 16, v164
    v_and_b32 v133, 0xffff0000, v164
    v_add_f32 v124, v124, v132
    v_add_f32 v126, v126, v133
    v_lshlrev_b32 v132, 16, v161
    v_and_b32 v133, 0xffff0000, v161
    v_add_f32 v123, v123, v132
    v_add_f32 v125, v125, v133
    v_lshlrev_b32 v132, 16, v165
    v_and_b32 v133, 0xffff0000, v165
    v_add_f32 v124, v124, v132
    v_add_f32 v126, v126, v133
    v_lshlrev_b32 v132, 16, v162
    v_and_b32 v133, 0xffff0000, v162
    v_add_f32 v123, v123, v132
    v_add_f32 v125, v125, v133
    v_lshlrev_b32 v132, 16, v166
    v_and_b32 v133, 0xffff0000, v166
    v_add_f32 v124, v124, v132
    v_add_f32 v126, v126, v133
    v_lshlrev_b32 v132, 16, v163
    v_and_b32 v133, 0xffff0000, v163
    v_add_f32 v123, v123, v132
    v_add_f32 v125, v125, v133
    v_lshlrev_b32 v132, 16, v167
    v_and_b32 v133, 0xffff0000, v167
    v_add_f32 v124, v124, v132
    v_add_f32 v126, v126, v133
    s_barrier
    v_add_f32 v123, v123, v125
    v_add_f32 v124, v124, v126
    s_mov_b32 s47, 1664525
    s_waitcnt vmcnt(0)
    v_mul_lo_u32 v134, v134, s47
    v_add_u32 v134, 1013904223, v134
    v_mov_b32 v136, v120
    v_mov_b32 v137, v121
    v_mov_b32 v138, v122
    v_mov_b32 v139, v123
    v_mov_b32 v140, v124
    v_mov_b32 v144, v128
    v_mov_b32 v145, v129
    v_mov_b32 v146, v130
    v_mov_b32 v147, v131
    v_cmp_gt_u32 vcc, 32, v0
    v_permlane32_swap_b32 v120, v136
    v_permlane32_swap_b32 v121, v137
    v_permlane32_swap_b32 v122, v138
    v_permlane32_swap_b32 v123, v139
    v_permlane32_swap_b32 v124, v140
    v_permlane32_swap_b32 v128, v144
    v_permlane32_swap_b32 v129, v145
    v_permlane32_swap_b32 v130, v146
    v_permlane32_swap_b32 v131, v147
    v_add_f32 v120, v120, v136
    v_add_f32 v121, v121, v137
    v_add_f32 v122, v122, v138
    v_add_f32 v123, v123, v139
    v_add_f32 v124, v124, v140
    v_add_f32 v128, v128, v144
    v_add_f32 v129, v129, v145
    v_add_f32 v130, v130, v146
    v_add_f32 v131, v131, v147
    v_cndmask_b32 v120, v123, v120, vcc
    v_cndmask_b32 v121, v124, v121, vcc
    v_mov_b32 v123, v134
    v_cndmask_b32 v128, v130, v128, vcc
    v_cndmask_b32 v129, v131, v129, vcc
    v_mov_b32 v131, v134
    buffer_store_dwordx4 v[120:123], v1, s[32:35], s50 offen sc1
    buffer_store_dwordx4 v[128:131], v1, s[32:35], s51 offen sc1
    s_barrier
    s_and_b32 s50, s50, 0xffffc7ff
    s_and_b32 s51, s51, 0xffffc7ff
    v_lshlrev_b32 v112, 2, v0
    v_mov_b32 v113, 163328
    v_mov_b32 v133, 0
    ds_write_b32 v113, v133
    ds_write_b32 v113, v134 offset:4
    v_mov_b32 v132, 0
    ds_write_b64 v113, v[132:133] offset:16
    ds_write_b64 v113, v[132:133] offset:24
    v_mov_b32 v3, v134
    s_lshl_b32 s54, s75, 3
    s_lshl_b32 s62, s46, 2
    s_add_u32 s54, s54, s62
    s_lshl_b32 s54, s54, 5
    s_add_u32 s54, s54, s74
    s_lshl_b32 s54, s54, 10
    s_add_u32 s54, s54, 0xd00000
    buffer_store_dwordx4 v[236:239], v1, s[32:35], s54 offen sc1
    s_add_u32 s54, s54, 0x8000
    s_barrier
    buffer_store_dwordx4 v[236:239], v1, s[32:35], s54 offen sc1
    s_add_u32 s54, s54, 0x8000
    s_barrier
    buffer_store_dwordx4 v[236:239], v1, s[32:35], s54 offen sc1
    s_add_u32 s54, s54, 0x8000
    s_barrier
    buffer_store_dwordx4 v[236:239], v1, s[32:35], s54 offen sc1
    s_add_u32 s54, s54, 0x8000
    s_barrier
    s_barrier
    s_barrier
    s_barrier
    s_barrier
    s_mov_b32 s53, 0
LM_gat:
    s_mov_b32 s47, s50
    s_mov_b32 s61, s51
    buffer_load_dwordx4 v[168:171], v1, s[32:35], s61 offen offset:0 sc1
    buffer_load_dwordx4 v[136:139], v1, s[32:35], s47 offen offset:0 sc1
    buffer_load_dwordx4 v[172:175], v1, s[32:35], s61 offen offset:2048 sc1
    buffer_load_dwordx4 v[140:143], v1, s[32:35], s47 offen offset:2048 sc1
    s_add_u32 s47, s47, 4096
    s_add_u32 s61, s61, 4096
    buffer_load_dwordx4 v[176:179], v1, s[32:35], s61 offen offset:0 sc1
    buffer_load_dwordx4 v[144:147], v1, s[32:35], s47 offen offset:0 sc1
    buffer_load_dwordx4 v[180:183], v1, s[32:35], s61 offen offset:2048 sc1
    buffer_load_dwordx4 v[148:151], v1, s[32:35], s47 offen offset:2048 sc1
    s_add_u32 s47, s47, 4096
    s_add_u32 s61, s61, 4096
    buffer_load_dwordx4 v[184:187], v1, s[32:35], s61 offen offset:0 sc1
    buffer_load_dwordx4 v[152:155], v1, s[32:35], s47 offen offset:0 sc1
    buffer_load_dwordx4 v[188:191], v1, s[32:35], s61 offen offset:2048 sc1
    buffer_load_dwordx4 v[156:159], v1, s[32:35], s47 offen offset:2048 sc1
    s_add_u32 s47, s47, 4096
    s_add_u32 s61, s61, 4096
    buffer_load_dwordx4 v[192:195], v1, s[32:35], s61 offen offset:0 sc1
    buffer_load_dwordx4 v[160:163], v1, s[32:35], s47 offen offset:0 sc1
    buffer_load_dwordx4 v[196:199], v1, s[32:35], s61 offen offset:2048 sc1
    buffer_load_dwordx4 v[164:167], v1, s[32:35], s47 offen offset:2048 sc1
    s_cmp_lg_u32 s53, 0
    s_cbranch_scc1 LM_chk
    s_barrier
    s_barrier
LM_chk:
    s_waitcnt vmcnt(0)
    s_add_u32 s53, s53, 1
    v_xor_b32 v114, v134, v139
    v_xor_b32 v115, v134, v143
    v_or_b32 v114, v114, v115
    v_xor_b32 v115, v134, v147
    v_or_b32 v114, v114, v115
    v_xor_b32 v115, v134, v151
    v_or_b32 v114, v114, v115
    v_xor_b32 v115, v134, v155
    v_or_b32 v114, v114, v115
    v_xor_b32 v115, v134, v159
    v_or_b32 v114, v114, v115
    v_xor_b32 v115, v134, v163
    v_or_b32 v114, v114, v115
    v_xor_b32 v115, v134, v167
    v_or_b32 v114, v114, v115
    v_xor_b32 v115, v134, v171
    v_or_b32 v114, v114, v115
    v_xor_b32 v115, v134, v175
    v_or_b32 v114, v114, v115
    v_xor_b32 v115, v134, v179
    v_or_b32 v114, v114, v115
    v_xor_b32 v115, v134, v183
    v_or_b32 v114, v114, v115
    v_xor_b32 v115, v134, v187
    v_or_b32 v114, v114, v115
    v_xor_b32 v115, v134, v191
    v_or_b32 v114, v114, v115
    v_xor_b32 v115, v134, v195
    v_or_b32 v114, v114, v115
    v_xor_b32 v115, v134, v199
    v_or_b32 v114, v114, v115
    v_cmp_ne_u32 vcc, 0, v114
    s_cbranch_vccz LM_red
    s_sleep 4
    s_cmp_lt_u32 s53, 262144
    s_cbranch_scc1 LM_gat
LM_red:
    v_add_f32 v168, v168, v172
    v_add_f32 v136, v136, v140
    v_add_f32 v169, v169, v173
    v_add_f32 v137, v137, v141
    v_add_f32 v138, v138, v142
    v_add_f32 v168, v168, v176
    v_add_f32 v136, v136, v144
    v_add_f32 v169, v169, v177
    v_add_f32 v137, v137, v145
    v_add_f32 v138, v138, v146
    v_add_f32 v168, v168, v180
    v_add_f32 v136, v136, v148
    v_add_f32 v169, v169, v181
    v_add_f32 v137, v137, v149
    v_add_f32 v138, v138, v150
    v_add_f32 v168, v168, v184
    v_add_f32 v136, v136, v152
    v_add_f32 v169, v169, v185
    v_add_f32 v137, v137, v153
    v_add_f32 v138, v138, v154
    v_add_f32 v168, v168, v188
    v_add_f32 v136, v136, v156
    v_add_f32 v169, v169, v189
    v_add_f32 v137, v137, v157
    v_add_f32 v138, v138, v158
    v_add_f32 v168, v168, v192
    v_add_f32 v136, v136, v160
    v_add_f32 v169, v169, v193
    v_add_f32 v137, v137, v161
    v_add_f32 v138, v138, v162
    v_add_f32 v168, v168, v196
    v_add_f32 v136, v136, v164
    v_add_f32 v169, v169, v197
    v_add_f32 v137, v137, v165
    v_add_f32 v138, v138, v166
    s_barrier
    s_mul_i32 s47, s46, 1280
    s_add_u32 s47, s47, 143360
    v_add_u32 v114, s47, v112
    s_lshl_b32 s47, s46, 9
    s_add_u32 s47, s47, 145920
    v_lshl_add_u32 v113, v0, 3, s47
    v_cmp_gt_u32 vcc, 32, v0
    v_mul_f32 v168, 0xbb000000, v168
    v_mul_f32 v169, 0x3b000000, v169
    v_fma_f32 v169, -v168, v168, v169
    v_max_f32 v169, 0, v169
    v_cvt_pk_bf16_f32 v169, v169, v169
    v_and_b32 v169, 0xffff0000, v169
    v_add_f32 v169, 0x3727c5ac, v169
    v_cvt_pk_bf16_f32 v169, v169, v169
    v_and_b32 v169, 0xffff0000, v169
    v_sqrt_f32 v169, v169
    v_cvt_pk_bf16_f32 v168, v168, v168
    v_cvt_pk_bf16_f32 v169, v169, v169
    v_and_b32 v169, 0xffff0000, v169
    ds_write_b64 v113, v[168:169]
    v_cvt_pk_bf16_f32 v132, v136, v136
    v_and_b32 v132, 0xffff0000, v132
    v_sub_f32 v133, v136, v132
    v_cvt_pk_bf16_f32 v132, v132, v133
    v_cndmask_b32 v120, 0, v132, vcc
    ds_write_b32 v114, v120 offset:0
    v_sub_u32 v124, v132, v120
    ds_write_b32 v114, v124 offset:768
    v_cvt_pk_bf16_f32 v132, v137, v137
    v_and_b32 v132, 0xffff0000, v132
    v_sub_f32 v133, v137, v132
    v_cvt_pk_bf16_f32 v132, v132, v133
    v_cndmask_b32 v121, 0, v132, vcc
    ds_write_b32 v114, v121 offset:256
    v_sub_u32 v125, v132, v121
    ds_write_b32 v114, v125 offset:1024
    v_cvt_pk_bf16_f32 v132, v138, v138
    v_and_b32 v132, 0xffff0000, v132
    v_sub_f32 v133, v138, v132
    v_cvt_pk_bf16_f32 v132, v132, v133
    v_cndmask_b32 v122, 0, v132, vcc
    ds_write_b32 v114, v122 offset:512
    s_waitcnt lgkmcnt(0)
    s_lshl_b32 s51, s2, 7
    s_add_u32 s51, s51, 0x13c0000
    s_cmp_lg_u32 s46, 0
    s_cmov_b32 s51, 0x2000000
    s_mov_b32 s52, 0x2000000
    s_cmp_eq_u32 s71, 3
    s_cselect_b32 s53, s51, s52
    s_cselect_b32 s51, s52, s51
    s_barrier
    s_barrier
    s_barrier
    s_barrier
    s_barrier
    s_barrier
    s_mov_b64 exec, 1
    buffer_store_dword v3, off, s[32:35], s51 sc1
    s_mov_b64 exec, -1
    s_barrier
    s_barrier
    s_mov_b64 exec, 1
    buffer_store_dword v3, off, s[32:35], s53 sc1
    s_mov_b64 exec, -1
    s_barrier
    s_barrier
    s_barrier
    s_load_dwordx2 s[24:25], s[0:1], 16
    s_mov_b32 s26, 524288
    s_mov_b32 s27, 0x20000
    s_lshl_b32 s47, s71, 1
    s_add_u32 s47, s47, s46
    s_lshl_b32 s47, s47, 16
    s_lshl_b32 s61, s70, 7
    s_add_u32 s47, s47, s61
    v_lshlrev_b32 v112, 10, v0
    s_waitcnt lgkmcnt(0)
    buffer_load_dword v241, v112, s[24:27], s47 offen
    s_barrier
    s_barrier
    s_barrier
    s_barrier
    s_setprio 2
LH_join:
    s_call_b64 s[8:9], LH_prep2
    s_lshl_b32 s61, s40, 2
    s_lshl_b32 s62, s46, 1
    s_add_u32 s61, s61, s62
    s_mul_i32 s61, s61, 112
    s_and_b32 s62, s3, 3
    s_mul_i32 s62, s62, 28
    s_add_u32 s61, s61, s62
    s_lshl_b32 s62, s71, 3
    s_add_u32 s61, s61, s62
    s_lshl_b32 s62, s45, 1
    s_add_u32 s61, s61, s62
    s_lshl_b32 s61, s61, 10
    s_add_u32 s64, s61, 0x600000
    s_add_u32 s66, s64, 4096
    s_cmp_eq_u32 s71, 3
    s_cselect_b32 s66, s64, s66
    s_add_u32 s67, s66, 114688
    s_and_b32 s47, s3, 3
    s_lshl_b32 s47, s47, 2
    s_add_u32 s47, s47, s45
    s_lshl_b32 s47, s47, 7
    s_lshl_b32 s62, s46, 4
    s_add_u32 s47, s47, s62
    s_add_u32 s47, s47, s40
    s_lshl_b32 s47, s47, 11
    s_add_u32 s47, s47, 0x210400
    s_cmp_eq_u32 s71, 3
    s_cselect_b32 s4, s47, s64
    s_movk_i32 s5, 1024
    s_cmov_b32 s5, 524288
    s_mov_b32 s6, 114688
    s_cmov_b32 s6, 131072
    s_add_u32 s6, s6, s4
    s_add_u32 s7, s6, s5
    s_add_u32 s5, s5, s4
    s_lshl_b32 s63, s2, 7
    s_lshl_b32 s62, s44, 2
    s_add_u32 s61, s63, s62
    s_add_u32 s61, s61, 0x13c8000
    s_lshl_b32 s50, s3, 3
    s_lshl_b32 s47, s71, 1
    s_add_u32 s50, s50, s47
    s_add_u32 s50, s50, s46
    s_lshl_b32 s51, s70, 1
    s_add_u32 s51, s51, s45
    s_mul_i32 s47, s44, 28672
    s_add_u32 s47, s47, 0x600000
    s_mul_i32 s56, s50, 114688
    s_add_u32 s56, s56, s47
    s_xor_b32 s57, s50, 1
    s_mul_i32 s57, s57, 114688
    s_add_u32 s57, s57, s47
    s_mul_i32 s58, s44, 458752
    s_lshl_b32 s47, s71, 1
    s_add_u32 s59, s70, s47
    s_cmp_ge_u32 s59, 7
    s_cselect_b32 s47, 7, 0
    s_sub_u32 s59, s59, s47
    s_lshl_b32 s59, s59, 12
    s_mov_b32 s49, 0x13c8000
    s_lshl_b32 s54, s50, 15
    s_lshl_b32 s47, s51, 6
    s_add_u32 s54, s54, s47
    s_load_dwordx2 s[20:21], s[0:1], 56
    s_load_dwordx2 s[36:37], s[0:1], 48
    s_load_dwordx2 s[24:25], s[0:1], 16
    s_mov_b32 s22, 2097152
    s_mov_b32 s38, 1835008
    s_mov_b32 s39, 0x20000
    s_mov_b32 s26, 524288
    s_mov_b32 s27, 0x20000
    s_waitcnt vmcnt(0) lgkmcnt(0)
    s_lshl_b32 s63, s44, 10
    s_lshl_b32 s47, s74, 17
    s_add_u32 s47, s47, 0x205000
    s_add_u32 s47, s47, s63
    s_add_u32 m0, s63, 20480
    s_barrier
    s_mov_b32 s48, 36864
    s_call_b64 s[8:9], LH_kv
    s_cmp_eq_u32 s71, 3
    s_cbranch_scc1 LH_vr
    ds_read_b128 v[96:99], v248 offset:0
    ds_read_b128 v[100:103], v248 offset:4096
    ds_read_b128 v[104:107], v248 offset:8192
    ds_read_b128 v[108:111], v248 offset:12288
    s_branch LH_hr
LH_vr:
    ds_read_b64_tr_b16 v[96:97], v230 offset:0
    ds_read_b64_tr_b16 v[98:99], v230 offset:64
    ds_read_b64_tr_b16 v[100:101], v230 offset:4096
    ds_read_b64_tr_b16 v[102:103], v230 offset:4160
    ds_read_b64_tr_b16 v[104:105], v230 offset:8192
    ds_read_b64_tr_b16 v[106:107], v230 offset:8256
    ds_read_b64_tr_b16 v[108:109], v230 offset:12288
    ds_read_b64_tr_b16 v[110:111], v230 offset:12352
LH_hr:
    ds_read_b128 v[112:115], v248 offset:16384
    ds_read_b128 v[116:119], v248 offset:20480
    ds_read_b128 v[120:123], v248 offset:24576
    ds_read_b128 v[124:127], v248 offset:28672
    s_waitcnt lgkmcnt(4)
    buffer_store_dwordx4 v[96:99], v1, s[32:35], s4 offen sc1
    s_waitcnt lgkmcnt(4)
    buffer_store_dwordx4 v[100:103], v1, s[32:35], s5 offen sc1
    s_waitcnt lgkmcnt(4)
    buffer_store_dwordx4 v[104:107], v1, s[32:35], s6 offen sc1
    s_waitcnt lgkmcnt(4)
    buffer_store_dwordx4 v[108:111], v1, s[32:35], s7 offen sc1
    s_waitcnt lgkmcnt(3)
    buffer_store_dwordx4 v[112:115], v1, s[32:35], s66 offen offset:0 sc1
    s_waitcnt lgkmcnt(2)
    buffer_store_dwordx4 v[116:119], v1, s[32:35], s66 offen offset:1024 sc1
    s_waitcnt lgkmcnt(1)
    buffer_store_dwordx4 v[120:123], v1, s[32:35], s67 offen offset:0 sc1
    s_waitcnt lgkmcnt(0)
    buffer_store_dwordx4 v[124:127], v1, s[32:35], s67 offen offset:1024 sc1
    s_waitcnt vmcnt(8)
    v_mov_b32 v241, 2
    ds_write_b32 v229, v241
    s_mov_b32 s48, 69632
    s_call_b64 s[8:9], LH_kv
    s_waitcnt vmcnt(8)
    s_or_b32 s62, s44, s2
    s_mov_b32 s62, 0x13d0000
    s_cmov_b32 s62, 0x2000000
    s_mov_b64 exec, 1
    buffer_store_dword v3, off, s[32:35], s61 sc1
    buffer_store_dword v3, off, s[32:35], s62 sc1
    s_mov_b64 exec, -1
    s_waitcnt vmcnt(2)
    v_mov_b32 v241, 4
    ds_write_b32 v229, v241
    s_lshl_b32 s55, s44, 17
LH_wo:
    buffer_load_dwordx4 v242, s[24:27], s55 offen lds
    s_add_u32 m0, m0, 4096
    s_add_u32 s55, s55, 8192
    s_cmp_lt_u32 m0, 131072
    s_cbranch_scc1 LH_wo
    s_mov_b32 m0, s60
    s_sub_u32 s62, s63, s60
    buffer_load_dwordx4 v242, s[24:27], s55 offen lds
    buffer_load_dwordx4 v[88:91], v249, s[16:19], s54 offen
    buffer_load_dwordx4 v[92:95], v249, s[16:19], s54 offen offset:32
    s_add_u32 s62, s62, 69632
    v_add_u32 v72, s62, v244
    v_add_u32 v73, s62, v245
    v_mov_b32 v251, v229
    s_add_u32 m0, s63, 65536
    s_sub_u32 s47, s47, 4096
    s_mov_b32 s48, 131072
    s_mov_b32 s63, 0
    s_waitcnt vmcnt(2)
    ds_read_b64_tr_b16 v[176:177], v72 offset:0
    ds_read_b64_tr_b16 v[178:179], v72 offset:4096
    ds_read_b64_tr_b16 v[180:181], v73 offset:0
    ds_read_b64_tr_b16 v[182:183], v73 offset:4096
    ds_read_b64_tr_b16 v[184:185], v72 offset:8192
    ds_read_b64_tr_b16 v[186:187], v72 offset:12288
    ds_read_b64_tr_b16 v[188:189], v73 offset:8192
    ds_read_b64_tr_b16 v[190:191], v73 offset:12288
    ds_read_b64_tr_b16 v[192:193], v72 offset:16384
    ds_read_b64_tr_b16 v[194:195], v72 offset:20480
    ds_read_b64_tr_b16 v[196:197], v73 offset:16384
    ds_read_b64_tr_b16 v[198:199], v73 offset:20480
    s_waitcnt lgkmcnt(0)
    ds_read_b64_tr_b16 v[200:201], v72 offset:24576
    ds_read_b64_tr_b16 v[202:203], v72 offset:28672
    ds_read_b64_tr_b16 v[204:205], v73 offset:24576
    ds_read_b64_tr_b16 v[206:207], v73 offset:28672
    ds_read_b64_tr_b16 v[208:209], v72 offset:32768
    ds_read_b64_tr_b16 v[210:211], v72 offset:36864
    ds_read_b64_tr_b16 v[212:213], v73 offset:32768
    ds_read_b64_tr_b16 v[214:215], v73 offset:36864
    ds_read_b64_tr_b16 v[216:217], v72 offset:40960
    ds_read_b64_tr_b16 v[218:219], v72 offset:45056
    ds_read_b64_tr_b16 v[220:221], v73 offset:40960
    ds_read_b64_tr_b16 v[222:223], v73 offset:45056
    s_waitcnt lgkmcnt(0)
    ds_read_b64_tr_b16 v[224:225], v72 offset:49152
    ds_read_b64_tr_b16 v[226:227], v72 offset:53248
    ds_read_b64_tr_b16 v[228:229], v73 offset:49152
    ds_read_b64_tr_b16 v[230:231], v73 offset:53248
    ds_read_b64_tr_b16 v[232:233], v72 offset:57344
    ds_read_b64_tr_b16 v[234:235], v244
    ds_read_b64_tr_b16 v[236:237], v73 offset:57344
    ds_read_b64_tr_b16 v[238:239], v245
    s_waitcnt lgkmcnt(0)
    s_cmp_lg_u32 s46, 0
    s_cbranch_scc1 LH_fh0
    s_call_b64 s[8:9], LH_kv
LH_fh0:
    buffer_load_dwordx4 v[76:79], v246, s[32:35], s49 offen sc1
LH_fh:
    s_add_u32 s63, s63, 1
    s_waitcnt vmcnt(0)
    v_cmp_ne_u64 vcc, v[2:3], v[76:77]
    v_cmp_ne_u64 s[4:5], v[2:3], v[78:79]
    s_or_b64 vcc, vcc, s[4:5]
    s_cbranch_scc0 LH_gemm
    s_sleep 8
    buffer_load_dwordx4 v[76:79], v246, s[32:35], s49 offen sc1
    s_cmp_lt_u32 s63, 262144
    s_cbranch_scc1 LH_fh
LH_gemm:
    s_cmp_eq_u32 s46, 0
    s_cbranch_scc1 LH_g0
    s_call_b64 s[8:9], LH_kv
LH_g0:
    s_mov_b32 s61, s59
    s_mov_b32 m0, s60
    v_mov_b32 v241, 8
    s_lshl_b32 s55, s59, 4
    s_add_u32 s55, s55, s58
    s_lshl_b32 s53, s70, 7
    s_add_u32 s55, s55, s53
    v_lshlrev_b32 v110, 6, v1
    buffer_load_dword v111, v110, s[36:39], s55 offen
    s_add_u32 s55, s55, 65536
    buffer_load_dword v111, v110, s[36:39], s55 offen
    s_add_u32 s52, s56, s59
    s_add_u32 s53, s57, s59
    s_lshl_b32 s55, s59, 4
    s_add_u32 s55, s55, s58
    s_add_u32 s59, s59, 4096
    s_cmp_ge_u32 s59, 28672
    s_cselect_b32 s59, 0, s59
    s_cmp_eq_u32 s59, s61
    s_cselect_b32 s59, 0x2000000, s59
    buffer_load_dwordx4 v[112:115], v1, s[32:35], s52 offen offset:0 sc1
    buffer_load_dwordx4 v[116:119], v1, s[32:35], s53 offen offset:0 sc1
    buffer_load_dwordx4 v242, s[36:39], s55 offen offset:0 lds
    buffer_load_dwordx4 v243, s[36:39], s55 offen offset:1024 lds
    s_add_u32 s55, s55, 14336
    buffer_load_dwordx4 v[120:123], v1, s[32:35], s52 offen offset:1024 sc1
    buffer_load_dwordx4 v[124:127], v1, s[32:35], s53 offen offset:1024 sc1
    buffer_load_dwordx4 v242, s[36:39], s55 offen offset:2048 lds
    buffer_load_dwordx4 v243, s[36:39], s55 offen offset:3072 lds
    s_add_u32 s55, s55, 18432
    s_waitcnt vmcnt(10)
    ds_write_b32 v251, v241
    s_waitcnt vmcnt(4)
    ds_read_b64_tr_b16 v[72:73], v244 offset:0
    ds_read_b64_tr_b16 v[74:75], v244 offset:1024
    ds_read_b64_tr_b16 v[76:77], v245 offset:0
    ds_read_b64_tr_b16 v[78:79], v245 offset:1024
    s_waitcnt lgkmcnt(0)
    buffer_load_dwordx4 v[128:131], v1, s[32:35], s52 offen offset:2048 sc1
    buffer_load_dwordx4 v[132:135], v1, s[32:35], s53 offen offset:2048 sc1
    buffer_load_dwordx4 v242, s[36:39], s55 offen offset:0 lds
    buffer_load_dwordx4 v243, s[36:39], s55 offen offset:1024 lds
    s_add_u32 s55, s55, 14336
    s_setprio 0
    s_mov_b32 s63, 0
LH_gloop:
    s_waitcnt vmcnt(4)
    ds_read_b64_tr_b16 v[80:81], v244 offset:2048
    ds_read_b64_tr_b16 v[82:83], v244 offset:3072
    ds_read_b64_tr_b16 v[84:85], v245 offset:2048
    ds_read_b64_tr_b16 v[86:87], v245 offset:3072
    v_mfma_f32_32x32x16_bf16 v[8:23], v[72:75], v[112:115], v[8:23]
    v_mfma_f32_32x32x16_bf16 v[24:39], v[72:75], v[116:119], v[24:39]
    s_waitcnt lgkmcnt(0)
    buffer_load_dwordx4 v[136:139], v1, s[32:35], s52 offen offset:3072 sc1
    buffer_load_dwordx4 v[140:143], v1, s[32:35], s53 offen offset:3072 sc1
    buffer_load_dwordx4 v242, s[36:39], s55 offen offset:2048 lds
    buffer_load_dwordx4 v243, s[36:39], s55 offen offset:3072 lds
    s_add_u32 s55, s55, 18432
    v_mfma_f32_32x32x16_bf16 v[40:55], v[76:79], v[112:115], v[40:55]
    v_mfma_f32_32x32x16_bf16 v[56:71], v[76:79], v[116:119], v[56:71]
    s_waitcnt vmcnt(4)
    ds_read_b64_tr_b16 v[72:73], v244 offset:0
    ds_read_b64_tr_b16 v[74:75], v244 offset:1024
    ds_read_b64_tr_b16 v[76:77], v245 offset:0
    ds_read_b64_tr_b16 v[78:79], v245 offset:1024
    v_mfma_f32_32x32x16_bf16 v[8:23], v[80:83], v[120:123], v[8:23]
    v_mfma_f32_32x32x16_bf16 v[24:39], v[80:83], v[124:127], v[24:39]
    s_waitcnt lgkmcnt(0)
    s_add_u32 s52, s56, s59
    s_add_u32 s53, s57, s59
    s_lshl_b32 s55, s59, 4
    s_add_u32 s55, s55, s58
    s_add_u32 s59, s59, 4096
    s_cmp_ge_u32 s59, 28672
    s_cselect_b32 s59, 0, s59
    s_cmp_eq_u32 s59, s61
    s_cselect_b32 s59, 0x2000000, s59
    buffer_load_dwordx4 v[112:115], v1, s[32:35], s52 offen offset:0 sc1
    buffer_load_dwordx4 v[116:119], v1, s[32:35], s53 offen offset:0 sc1
    buffer_load_dwordx4 v242, s[36:39], s55 offen offset:0 lds
    buffer_load_dwordx4 v243, s[36:39], s55 offen offset:1024 lds
    s_add_u32 s55, s55, 14336
    v_mfma_f32_32x32x16_bf16 v[40:55], v[84:87], v[120:123], v[40:55]
    v_mfma_f32_32x32x16_bf16 v[56:71], v[84:87], v[124:127], v[56:71]
    s_waitcnt vmcnt(4)
    ds_read_b64_tr_b16 v[80:81], v244 offset:2048
    ds_read_b64_tr_b16 v[82:83], v244 offset:3072
    ds_read_b64_tr_b16 v[84:85], v245 offset:2048
    ds_read_b64_tr_b16 v[86:87], v245 offset:3072
    v_mfma_f32_32x32x16_bf16 v[8:23], v[72:75], v[128:131], v[8:23]
    v_mfma_f32_32x32x16_bf16 v[24:39], v[72:75], v[132:135], v[24:39]
    s_waitcnt lgkmcnt(0)
    buffer_load_dwordx4 v[120:123], v1, s[32:35], s52 offen offset:1024 sc1
    buffer_load_dwordx4 v[124:127], v1, s[32:35], s53 offen offset:1024 sc1
    buffer_load_dwordx4 v242, s[36:39], s55 offen offset:2048 lds
    buffer_load_dwordx4 v243, s[36:39], s55 offen offset:3072 lds
    s_add_u32 s55, s55, 18432
    v_mfma_f32_32x32x16_bf16 v[40:55], v[76:79], v[128:131], v[40:55]
    v_mfma_f32_32x32x16_bf16 v[56:71], v[76:79], v[132:135], v[56:71]
    s_waitcnt vmcnt(4)
    ds_read_b64_tr_b16 v[72:73], v244 offset:0
    ds_read_b64_tr_b16 v[74:75], v244 offset:1024
    ds_read_b64_tr_b16 v[76:77], v245 offset:0
    ds_read_b64_tr_b16 v[78:79], v245 offset:1024
    v_mfma_f32_32x32x16_bf16 v[8:23], v[80:83], v[136:139], v[8:23]
    v_mfma_f32_32x32x16_bf16 v[24:39], v[80:83], v[140:143], v[24:39]
    s_waitcnt lgkmcnt(0)
    buffer_load_dwordx4 v[128:131], v1, s[32:35], s52 offen offset:2048 sc1
    buffer_load_dwordx4 v[132:135], v1, s[32:35], s53 offen offset:2048 sc1
    buffer_load_dwordx4 v242, s[36:39], s55 offen offset:0 lds
    buffer_load_dwordx4 v243, s[36:39], s55 offen offset:1024 lds
    s_add_u32 s55, s55, 14336
    v_mfma_f32_32x32x16_bf16 v[40:55], v[84:87], v[136:139], v[40:55]
    v_mfma_f32_32x32x16_bf16 v[56:71], v[84:87], v[140:143], v[56:71]
    s_add_u32 s63, s63, 1
    s_cmp_lt_u32 s63, 7
    s_cbranch_scc1 LH_gloop
    s_setprio 0
    s_lshl_b32 s47, s3, 3
    s_lshl_b32 s61, s44, 1
    s_add_u32 s47, s47, s61
    s_lshl_b32 s47, s47, 7
    s_lshl_b32 s61, s71, 2
    s_add_u32 s47, s47, s61
    s_add_u32 s47, s47, 0x13c8000
    s_mov_b32 s63, 0
LH_fs:
    buffer_load_dword v241, v250, s[32:35], s47 offen sc1
    s_add_u32 s63, s63, 1
    s_waitcnt vmcnt(0)
    v_cmp_ne_u32 vcc, v3, v241
    s_cbranch_vccz LH_fsok
    s_sleep 8
    s_cmp_lt_u32 s63, 262144
    s_cbranch_scc1 LH_fs
LH_fsok:
    s_mov_b32 s62, 0
    s_call_b64 s[8:9], LH_meet
    ds_write_b128 v5, v[24:27] offset:0
    ds_write_b128 v5, v[28:31] offset:1024
    ds_write_b128 v5, v[32:35] offset:2048
    ds_write_b128 v5, v[36:39] offset:3072
    s_call_b64 s[8:9], LH_meet
    ds_read_b128 v[24:27], v4 offset:0
    ds_read_b128 v[28:31], v4 offset:1024
    ds_read_b128 v[32:35], v4 offset:2048
    ds_read_b128 v[36:39], v4 offset:3072
    s_call_b64 s[8:9], LH_meet
    ds_write_b128 v6, v[40:43] offset:0
    ds_write_b128 v6, v[44:47] offset:1024
    ds_write_b128 v6, v[48:51] offset:2048
    ds_write_b128 v6, v[52:55] offset:3072
    s_call_b64 s[8:9], LH_meet
    ds_read_b128 v[40:43], v4 offset:0
    ds_read_b128 v[44:47], v4 offset:1024
    ds_read_b128 v[48:51], v4 offset:2048
    ds_read_b128 v[52:55], v4 offset:3072
    s_call_b64 s[8:9], LH_meet
    ds_write_b128 v7, v[56:59] offset:0
    ds_write_b128 v7, v[60:63] offset:1024
    ds_write_b128 v7, v[64:67] offset:2048
    ds_write_b128 v7, v[68:71] offset:3072
    s_call_b64 s[8:9], LH_meet
    ds_read_b128 v[56:59], v4 offset:0
    ds_read_b128 v[60:63], v4 offset:1024
    ds_read_b128 v[64:67], v4 offset:2048
    ds_read_b128 v[68:71], v4 offset:3072
    s_lshl_b32 s52, s50, 5
    s_lshl_b32 s61, s44, 3
    s_add_u32 s52, s52, s61
    s_lshl_b32 s52, s52, 10
    s_add_u32 s58, s52, 0xd00000
    s_xor_b32 s56, s58, 0x8000
    s_add_u32 s57, s56, 4096
    s_add_u32 s59, s58, 4096
    s_mov_b32 s63, 0
    s_mov_b32 s52, -1
    s_waitcnt lgkmcnt(0)
    s_barrier
LH_o0:
    buffer_load_dwordx4 v[112:115], v1, s[32:35], s56 offen offset:0 sc1
    buffer_load_dwordx4 v[116:119], v1, s[32:35], s56 offen offset:1024 sc1
    buffer_load_dwordx4 v[120:123], v1, s[32:35], s56 offen offset:2048 sc1
    buffer_load_dwordx4 v[124:127], v1, s[32:35], s56 offen offset:3072 sc1
LH_o1:
    buffer_load_dwordx4 v[128:131], v1, s[32:35], s57 offen offset:0 sc1
    buffer_load_dwordx4 v[132:135], v1, s[32:35], s57 offen offset:1024 sc1
    buffer_load_dwordx4 v[136:139], v1, s[32:35], s57 offen offset:2048 sc1
    buffer_load_dwordx4 v[140:143], v1, s[32:35], s57 offen offset:3072 sc1
LH_o2:
    buffer_load_dwordx4 v[144:147], v1, s[32:35], s58 offen offset:0 sc1
    buffer_load_dwordx4 v[148:151], v1, s[32:35], s58 offen offset:1024 sc1
    buffer_load_dwordx4 v[152:155], v1, s[32:35], s58 offen offset:2048 sc1
    buffer_load_dwordx4 v[156:159], v1, s[32:35], s58 offen offset:3072 sc1
LH_o3:
    buffer_load_dwordx4 v[160:163], v1, s[32:35], s59 offen offset:0 sc1
    buffer_load_dwordx4 v[164:167], v1, s[32:35], s59 offen offset:1024 sc1
    buffer_load_dwordx4 v[168:171], v1, s[32:35], s59 offen offset:2048 sc1
    buffer_load_dwordx4 v[172:175], v1, s[32:35], s59 offen offset:3072 sc1
    s_cmp_eq_u32 s52, 0
    s_cbranch_scc1 LH_c0
    s_cmp_eq_u32 s52, 1
    s_cbranch_scc1 LH_c1
    s_cmp_eq_u32 s52, 2
    s_cbranch_scc1 LH_c2
    s_cmp_eq_u32 s52, 3
    s_cbranch_scc1 LH_c3
    s_mov_b32 s4, 0xbfb8aa3b
    s_mov_b32 s5, 1.0
    v_pk_add_f32 v[8:9], v[8:9], v[24:25]
    v_pk_add_f32 v[10:11], v[10:11], v[26:27]
    v_pk_add_f32 v[12:13], v[12:13], v[28:29]
    v_pk_add_f32 v[14:15], v[14:15], v[30:31]
    v_pk_add_f32 v[16:17], v[16:17], v[32:33]
    v_pk_add_f32 v[18:19], v[18:19], v[34:35]
    v_pk_add_f32 v[20:21], v[20:21], v[36:37]
    v_pk_add_f32 v[22:23], v[22:23], v[38:39]
    v_pk_add_f32 v[8:9], v[8:9], v[40:41]
    v_pk_add_f32 v[10:11], v[10:11], v[42:43]
    v_pk_add_f32 v[12:13], v[12:13], v[44:45]
    v_pk_add_f32 v[14:15], v[14:15], v[46:47]
    v_pk_add_f32 v[16:17], v[16:17], v[48:49]
    v_pk_add_f32 v[18:19], v[18:19], v[50:51]
    v_pk_add_f32 v[20:21], v[20:21], v[52:53]
    v_pk_add_f32 v[22:23], v[22:23], v[54:55]
    v_pk_add_f32 v[72:73], v[8:9], v[56:57]
    v_pk_add_f32 v[74:75], v[10:11], v[58:59]
    v_pk_add_f32 v[76:77], v[12:13], v[60:61]
    v_pk_add_f32 v[78:79], v[14:15], v[62:63]
    v_pk_add_f32 v[80:81], v[16:17], v[64:65]
    v_pk_add_f32 v[82:83], v[18:19], v[66:67]
    v_pk_add_f32 v[84:85], v[20:21], v[68:69]
    v_pk_add_f32 v[86:87], v[22:23], v[70:71]
    v_pk_mul_f32 v[8:9], v[72:73], s[4:5] op_sel_hi:[1,0]
    v_pk_mul_f32 v[10:11], v[74:75], s[4:5] op_sel_hi:[1,0]
    v_pk_mul_f32 v[12:13], v[76:77], s[4:5] op_sel_hi:[1,0]
    v_pk_mul_f32 v[14:15], v[78:79], s[4:5] op_sel_hi:[1,0]
    v_pk_mul_f32 v[16:17], v[80:81], s[4:5] op_sel_hi:[1,0]
    v_pk_mul_f32 v[18:19], v[82:83], s[4:5] op_sel_hi:[1,0]
    v_pk_mul_f32 v[20:21], v[84:85], s[4:5] op_sel_hi:[1,0]
    v_pk_mul_f32 v[22:23], v[86:87], s[4:5] op_sel_hi:[1,0]
    v_exp_f32 v8, v8
    v_exp_f32 v9, v9
    v_exp_f32 v10, v10
    v_exp_f32 v11, v11
    v_exp_f32 v12, v12
    v_exp_f32 v13, v13
    v_exp_f32 v14, v14
    v_exp_f32 v15, v15
    v_exp_f32 v16, v16
    v_exp_f32 v17, v17
    v_exp_f32 v18, v18
    v_exp_f32 v19, v19
    v_exp_f32 v20, v20
    v_exp_f32 v21, v21
    v_exp_f32 v22, v22
    v_exp_f32 v23, v23
    v_pk_add_f32 v[8:9], v[8:9], s[4:5] op_sel:[0,1] op_sel_hi:[1,1]
    v_pk_add_f32 v[10:11], v[10:11], s[4:5] op_sel:[0,1] op_sel_hi:[1,1]
    v_pk_add_f32 v[12:13], v[12:13], s[4:5] op_sel:[0,1] op_sel_hi:[1,1]
    v_pk_add_f32 v[14:15], v[14:15], s[4:5] op_sel:[0,1] op_sel_hi:[1,1]
    v_pk_add_f32 v[16:17], v[16:17], s[4:5] op_sel:[0,1] op_sel_hi:[1,1]
    v_pk_add_f32 v[18:19], v[18:19], s[4:5] op_sel:[0,1] op_sel_hi:[1,1]
    v_pk_add_f32 v[20:21], v[20:21], s[4:5] op_sel:[0,1] op_sel_hi:[1,1]
    v_pk_add_f32 v[22:23], v[22:23], s[4:5] op_sel:[0,1] op_sel_hi:[1,1]
    v_rcp_f32 v8, v8
    v_rcp_f32 v9, v9
    v_rcp_f32 v10, v10
    v_rcp_f32 v11, v11
    v_rcp_f32 v12, v12
    v_rcp_f32 v13, v13
    v_rcp_f32 v14, v14
    v_rcp_f32 v15, v15
    v_rcp_f32 v16, v16
    v_rcp_f32 v17, v17
    v_rcp_f32 v18, v18
    v_rcp_f32 v19, v19
    v_rcp_f32 v20, v20
    v_rcp_f32 v21, v21
    v_rcp_f32 v22, v22
    v_rcp_f32 v23, v23
    v_pk_mul_f32 v[72:73], v[8:9], v[72:73]
    v_pk_mul_f32 v[74:75], v[10:11], v[74:75]
    v_pk_mul_f32 v[76:77], v[12:13], v[76:77]
    v_pk_mul_f32 v[78:79], v[14:15], v[78:79]
    v_pk_mul_f32 v[80:81], v[16:17], v[80:81]
    v_pk_mul_f32 v[82:83], v[18:19], v[82:83]
    v_pk_mul_f32 v[84:85], v[20:21], v[84:85]
    v_pk_mul_f32 v[86:87], v[22:23], v[86:87]
LH_c0:
    s_mov_b32 s52, 0
    s_add_u32 s63, s63, 1
    s_waitcnt vmcnt(12)
    v_max3_u32 v241, v112, v116, v120
    v_max_u32 v241, v241, v124
    v_cmp_eq_u32 vcc, -1, v241
    s_cbranch_vccz LH_m0
    s_sleep 4
    s_cmp_lt_u32 s63, 262144
    s_cbranch_scc1 LH_o0
LH_m0:
    v_mfma_f32_32x32x16_bf16 v[56:71], v[180:183], v[112:115], 0
    v_mfma_f32_32x32x16_bf16 v[56:71], v[188:191], v[116:119], v[56:71]
    v_mfma_f32_32x32x16_bf16 v[56:71], v[196:199], v[120:123], v[56:71]
    v_mfma_f32_32x32x16_bf16 v[56:71], v[204:207], v[124:127], v[56:71]
    v_mfma_f32_32x32x16_bf16 v[24:39], v[176:179], v[112:115], 0
    v_mfma_f32_32x32x16_bf16 v[24:39], v[184:187], v[116:119], v[24:39]
    v_mfma_f32_32x32x16_bf16 v[24:39], v[192:195], v[120:123], v[24:39]
    v_mfma_f32_32x32x16_bf16 v[24:39], v[200:203], v[124:127], v[24:39]
LH_c1:
    s_mov_b32 s52, 1
    s_add_u32 s63, s63, 1
    s_waitcnt vmcnt(8)
    v_max3_u32 v241, v128, v132, v136
    v_max_u32 v241, v241, v140
    v_cmp_eq_u32 vcc, -1, v241
    s_cbranch_vccz LH_m1
    s_sleep 4
    s_cmp_lt_u32 s63, 262144
    s_cbranch_scc1 LH_o1
LH_m1:
    v_mfma_f32_32x32x16_bf16 v[56:71], v[212:215], v[128:131], v[56:71]
    v_mfma_f32_32x32x16_bf16 v[56:71], v[220:223], v[132:135], v[56:71]
    v_mfma_f32_32x32x16_bf16 v[56:71], v[228:231], v[136:139], v[56:71]
    v_mfma_f32_32x32x16_bf16 v[56:71], v[236:239], v[140:143], v[56:71]
    v_mfma_f32_32x32x16_bf16 v[24:39], v[208:211], v[128:131], v[24:39]
    v_mfma_f32_32x32x16_bf16 v[24:39], v[216:219], v[132:135], v[24:39]
    v_mfma_f32_32x32x16_bf16 v[24:39], v[224:227], v[136:139], v[24:39]
    v_mfma_f32_32x32x16_bf16 v[24:39], v[232:235], v[140:143], v[24:39]
LH_c2:
    s_mov_b32 s52, 2
    s_add_u32 s63, s63, 1
    s_waitcnt vmcnt(4)
    v_max3_u32 v241, v144, v148, v152
    v_max_u32 v241, v241, v156
    v_cmp_eq_u32 vcc, -1, v241
    s_cbranch_vccz LH_m2
    s_sleep 4
    s_cmp_lt_u32 s63, 262144
    s_cbranch_scc1 LH_o2
LH_m2:
    v_mfma_f32_32x32x16_bf16 v[40:55], v[180:183], v[144:147], 0
    ds_write_b128 v255, v[56:59] offset:8192
    v_mfma_f32_32x32x16_bf16 v[40:55], v[188:191], v[148:151], v[40:55]
    ds_write_b128 v255, v[60:63] offset:9216
    v_mfma_f32_32x32x16_bf16 v[40:55], v[196:199], v[152:155], v[40:55]
    ds_write_b128 v255, v[64:67] offset:10240
    v_mfma_f32_32x32x16_bf16 v[40:55], v[204:207], v[156:159], v[40:55]
    ds_write_b128 v255, v[68:71] offset:11264
    v_mfma_f32_32x32x16_bf16 v[8:23], v[176:179], v[144:147], 0
    ds_write_b128 v253, v[24:27] offset:0
    v_mfma_f32_32x32x16_bf16 v[8:23], v[184:187], v[148:151], v[8:23]
    ds_write_b128 v253, v[28:31] offset:1024
    v_mfma_f32_32x32x16_bf16 v[8:23], v[192:195], v[152:155], v[8:23]
    ds_write_b128 v253, v[32:35] offset:2048
    v_mfma_f32_32x32x16_bf16 v[8:23], v[200:203], v[156:159], v[8:23]
    ds_write_b128 v253, v[36:39] offset:3072
LH_c3:
    s_mov_b32 s52, 3
    s_add_u32 s63, s63, 1
    s_waitcnt vmcnt(0)
    v_max3_u32 v241, v160, v164, v168
    v_max_u32 v241, v241, v172
    v_cmp_eq_u32 vcc, -1, v241
    s_cbranch_vccz LH_m3
    s_sleep 4
    s_cmp_lt_u32 s63, 262144
    s_cbranch_scc1 LH_o3
LH_m3:
    v_mfma_f32_32x32x16_bf16 v[40:55], v[212:215], v[160:163], v[40:55]
    v_lshlrev_b32 v96, 16, v88
    v_and_b32 v97, 0xffff0000, v88
    v_mfma_f32_32x32x16_bf16 v[40:55], v[220:223], v[164:167], v[40:55]
    v_lshlrev_b32 v98, 16, v89
    v_and_b32 v99, 0xffff0000, v89
    v_mfma_f32_32x32x16_bf16 v[40:55], v[228:231], v[168:171], v[40:55]
    v_lshlrev_b32 v100, 16, v90
    v_and_b32 v101, 0xffff0000, v90
    v_mfma_f32_32x32x16_bf16 v[40:55], v[236:239], v[172:175], v[40:55]
    v_lshlrev_b32 v102, 16, v91
    v_and_b32 v103, 0xffff0000, v91
    v_mfma_f32_32x32x16_bf16 v[8:23], v[208:211], v[160:163], v[8:23]
    v_lshlrev_b32 v104, 16, v92
    v_and_b32 v105, 0xffff0000, v92
    v_mfma_f32_32x32x16_bf16 v[8:23], v[216:219], v[164:167], v[8:23]
    v_lshlrev_b32 v106, 16, v93
    v_and_b32 v107, 0xffff0000, v93
    v_mfma_f32_32x32x16_bf16 v[8:23], v[224:227], v[168:171], v[8:23]
    v_lshlrev_b32 v108, 16, v94
    v_and_b32 v109, 0xffff0000, v94
    v_mfma_f32_32x32x16_bf16 v[8:23], v[232:235], v[172:175], v[8:23]
    v_lshlrev_b32 v110, 16, v95
    v_and_b32 v111, 0xffff0000, v95
    ds_write_b128 v254, v[40:43] offset:4096
    ds_write_b128 v254, v[44:47] offset:5120
    ds_write_b128 v254, v[48:51] offset:6144
    ds_write_b128 v254, v[52:55] offset:7168
    s_waitcnt lgkmcnt(0)
    s_barrier
    ds_read_b128 v[24:27], v252 offset:0
    ds_read_b128 v[28:31], v252 offset:1024
    ds_read_b128 v[32:35], v252 offset:2048
    ds_read_b128 v[36:39], v252 offset:3072
    ds_read_b128 v[40:43], v252 offset:4096
    ds_read_b128 v[44:47], v252 offset:5120
    ds_read_b128 v[48:51], v252 offset:6144
    ds_read_b128 v[52:55], v252 offset:7168
    ds_read_b128 v[56:59], v252 offset:8192
    ds_read_b128 v[60:63], v252 offset:9216
    ds_read_b128 v[64:67], v252 offset:10240
    ds_read_b128 v[68:71], v252 offset:11264
    s_waitcnt lgkmcnt(8)
    v_pk_add_f32 v[8:9], v[8:9], v[24:25]
    v_pk_add_f32 v[10:11], v[10:11], v[26:27]
    v_pk_add_f32 v[12:13], v[12:13], v[28:29]
    v_pk_add_f32 v[14:15], v[14:15], v[30:31]
    v_pk_add_f32 v[16:17], v[16:17], v[32:33]
    v_pk_add_f32 v[18:19], v[18:19], v[34:35]
    v_pk_add_f32 v[20:21], v[20:21], v[36:37]
    v_pk_add_f32 v[22:23], v[22:23], v[38:39]
    s_waitcnt lgkmcnt(4)
    v_pk_add_f32 v[8:9], v[8:9], v[40:41]
    v_pk_add_f32 v[10:11], v[10:11], v[42:43]
    v_pk_add_f32 v[12:13], v[12:13], v[44:45]
    v_pk_add_f32 v[14:15], v[14:15], v[46:47]
    v_pk_add_f32 v[16:17], v[16:17], v[48:49]
    v_pk_add_f32 v[18:19], v[18:19], v[50:51]
    v_pk_add_f32 v[20:21], v[20:21], v[52:53]
    v_pk_add_f32 v[22:23], v[22:23], v[54:55]
    s_waitcnt lgkmcnt(3)
    v_pk_add_f32 v[8:9], v[8:9], v[56:57]
    v_pk_fma_f32 v[8:9], v[8:9], v[72:73], v[96:97]
    v_cvt_pk_bf16_f32 v88, v8, v9
    v_pk_add_f32 v[10:11], v[10:11], v[58:59]
    v_pk_fma_f32 v[10:11], v[10:11], v[74:75], v[98:99]
    v_cvt_pk_bf16_f32 v89, v10, v11
    s_waitcnt lgkmcnt(2)
    v_pk_add_f32 v[12:13], v[12:13], v[60:61]
    v_pk_fma_f32 v[12:13], v[12:13], v[76:77], v[100:101]
    v_cvt_pk_bf16_f32 v90, v12, v13
    v_pk_add_f32 v[14:15], v[14:15], v[62:63]
    v_pk_fma_f32 v[14:15], v[14:15], v[78:79], v[102:103]
    v_cvt_pk_bf16_f32 v91, v14, v15
    buffer_store_dwordx4 v[88:91], v249, s[20:23], s54 offen offset:0
    s_waitcnt lgkmcnt(1)
    v_pk_add_f32 v[16:17], v[16:17], v[64:65]
    v_pk_fma_f32 v[16:17], v[16:17], v[80:81], v[104:105]
    v_cvt_pk_bf16_f32 v92, v16, v17
    v_pk_add_f32 v[18:19], v[18:19], v[66:67]
    v_pk_fma_f32 v[18:19], v[18:19], v[82:83], v[106:107]
    v_cvt_pk_bf16_f32 v93, v18, v19
    s_waitcnt lgkmcnt(0)
    v_pk_add_f32 v[20:21], v[20:21], v[68:69]
    v_pk_fma_f32 v[20:21], v[20:21], v[84:85], v[108:109]
    v_cvt_pk_bf16_f32 v94, v20, v21
    v_pk_add_f32 v[22:23], v[22:23], v[70:71]
    v_pk_fma_f32 v[22:23], v[22:23], v[86:87], v[110:111]
    v_cvt_pk_bf16_f32 v95, v22, v23
    buffer_store_dwordx4 v[92:95], v249, s[20:23], s54 offen offset:32
    s_endpgm
LH_meet:
    s_add_u32 s62, s62, 4
    s_mov_b32 s63, 0
    s_waitcnt lgkmcnt(0)
    s_mov_b64 exec, 1
    ds_add_u32 v247, v240
    s_mov_b64 exec, -1
LH_meetw:
    ds_read_b32 v241, v247
    s_add_u32 s63, s63, 1
    s_waitcnt lgkmcnt(0)
    v_cmp_gt_u32 vcc, s62, v241
    s_cbranch_vccz LH_meetok
    s_sleep 4
    s_cmp_lt_u32 s63, 4194304
    s_cbranch_scc1 LH_meetw
LH_meetok:
    s_setpc_b64 s[8:9]
LH_kv:
    buffer_load_dwordx4 v1, s[32:35], s47 offen sc1 lds
    s_add_u32 m0, m0, 4096
    s_add_u32 s47, s47, 4096
    s_cmp_lt_u32 m0, s48
    s_cbranch_scc1 LH_kv
    s_setpc_b64 s[8:9]
LH_prep:
    v_lshlrev_b32 v1, 4, v0
    v_cmp_gt_u32 vcc, 32, v0
    v_and_b32 v200, 15, v0
    v_and_b32 v201, 1, v0
    s_lshl_b32 s47, s75, 1
    v_add_u32 v201, s47, v201
    s_add_u32 s61, s3, 8
    s_lshr_b32 s62, s3, 1
    s_lshl_b32 s62, s62, 2
    s_add_u32 s62, s62, 3
    v_cndmask_b32 v200, v201, v200, vcc
    v_mov_b32 v201, s3
    v_mov_b32 v202, s62
    v_cndmask_b32 v201, v201, v202, vcc
    v_cmp_gt_u32 vcc, 16, v0
    v_mov_b32 v202, s61
    v_lshrrev_b32 v203, 3, v200
    v_cndmask_b32 v201, v201, v202, vcc
    v_and_b32 v200, 7, v200
    v_lshlrev_b32 v200, 3, v200
    v_lshl_add_u32 v200, v203, 2, v200
    v_lshrrev_b32 v203, 2, v201
    v_add_u32 v200, v200, v203
    v_and_b32 v201, 3, v201
    v_lshl_add_u32 v200, v201, 6, v200
    v_lshlrev_b32 v251, 7, v200
    s_lshl_b32 s61, s44, 12
    s_add_u32 s47, s61, 131072
    s_add_u32 s61, s61, 146944
    v_and_b32 v204, 11, v0
    v_cmp_eq_u32 vcc, 0, v204
    v_mov_b32 v204, 0x45804580
    v_and_b32 v205, 0x1ff, v1
    v_cndmask_b32 v232, 0, v204, vcc
    v_add_u32 v231, s47, v205
    v_mov_b32 v233, v232
    v_mov_b64 v[234:235], v[232:233]
    v_mov_b32 v240, 1
    v_mov_b32 v247, 163328
    v_mov_b64 v[236:237], -1
    v_mov_b64 v[238:239], -1
    s_lshl_b32 s47, s44, 10
    s_add_u32 s47, s47, 98304
    v_add_u32 v248, s47, v1
    v_lshrrev_b32 v207, 5, v0
    v_bfe_u32 v204, v0, 4, 1
    v_lshl_add_u32 v204, v204, 2, v207
    v_bfe_u32 v205, v0, 2, 2
    v_lshl_add_u32 v204, v204, 2, v205
    v_and_b32 v205, 3, v0
    v_lshlrev_b32 v205, 8, v205
    v_lshl_add_u32 v204, v204, 3, v205
    v_add_u32 v230, s47, v204
    v_lshrrev_b32 v204, 3, v0
    v_and_b32 v205, 7, v0
    v_and_b32 v206, 2, v204
    v_lshlrev_b32 v206, 1, v206
    v_xor_b32 v205, v205, v206
    v_lshlrev_b32 v205, 4, v205
    v_lshl_add_u32 v242, v204, 10, v205
    s_lshl_b32 s47, s70, 7
    v_add_u32 v242, s47, v242
    v_add_u32 v243, 7168, v242
    v_and_b32 v205, 1, v0
    v_bfe_u32 v204, v0, 1, 1
    v_lshl_add_u32 v205, v205, 1, v204
    v_lshlrev_b32 v205, 3, v205
    v_bfe_u32 v204, v0, 4, 1
    v_lshl_add_u32 v205, v204, 5, v205
    v_bfe_u32 v206, v0, 2, 2
    v_lshl_add_u32 v204, v207, 2, v206
    v_lshl_add_u32 v205, v204, 7, v205
    v_bfe_u32 v204, v0, 3, 1
    v_xor_b32 v204, s45, v204
    v_lshl_add_u32 v205, v204, 6, v205
    v_add_u32 v244, s61, v205
    v_xor_b32 v245, 64, v244
    v_and_b32 v205, 3, v0
    v_lshl_add_u32 v246, v206, 6, v205
    s_lshl_b32 s47, s3, 1
    s_lshr_b32 s62, s71, 1
    s_add_u32 s47, s47, s62
    s_and_b32 s62, s47, 7
    s_lshl_b32 s62, s62, 3
    s_lshr_b32 s47, s47, 3
    s_lshl_b32 s47, s47, 2
    s_add_u32 s47, s47, s62
    v_add_lshl_u32 v246, v246, s47, 7
    v_lshrrev_b32 v204, 4, v0
    v_cmp_eq_u32 vcc, 1, v204
    s_lshl_b32 s47, s44, 2
    s_add_u32 s47, s47, 163344
    v_cndmask_b32 v246, v246, v251, vcc
    v_mov_b32 v229, s47
    v_bfe_u32 v204, v0, 2, 1
    v_lshl_add_u32 v250, v205, 6, v204
    v_lshlrev_b32 v250, 7, v250
    v_and_b32 v204, 31, v0
    v_lshlrev_b32 v204, 10, v204
    v_lshl_add_u32 v249, v207, 4, v204
    v_mov_b64 v[224:225], 0
    v_mov_b64 v[226:227], 0
    s_xor_b32 s47, s44, 0
    s_lshl_b32 s47, s47, 14
    v_add_u32 v252, s47, v1
    v_mfma_f32_32x32x16_bf16 v[8:23], v[224:227], v[224:227], 0
    s_xor_b32 s47, s44, 1
    s_lshl_b32 s47, s47, 14
    v_add_u32 v253, s47, v1
    v_mfma_f32_32x32x16_bf16 v[24:39], v[224:227], v[224:227], 0
    s_xor_b32 s47, s44, 2
    s_lshl_b32 s47, s47, 14
    v_add_u32 v254, s47, v1
    v_mfma_f32_32x32x16_bf16 v[40:55], v[224:227], v[224:227], 0
    s_xor_b32 s47, s44, 3
    s_lshl_b32 s47, s47, 14
    v_add_u32 v255, s47, v1
    v_mfma_f32_32x32x16_bf16 v[56:71], v[224:227], v[224:227], 0
    s_setpc_b64 s[8:9]
LH_prep2:
    ds_write_b128 v231, v[232:235]
    ds_write_b128 v231, v[232:235] offset:2048
    s_lshl_b32 s60, s44, 12
    s_add_u32 s60, s60, 146944
    s_xor_b32 s47, s44, 0
    s_lshl_b32 s47, s47, 12
    s_add_u32 s47, s47, 146944
    v_add_u32 v4, s47, v1
    s_xor_b32 s47, s44, 1
    s_lshl_b32 s47, s47, 12
    s_add_u32 s47, s47, 146944
    v_add_u32 v5, s47, v1
    s_xor_b32 s47, s44, 2
    s_lshl_b32 s47, s47, 12
    s_add_u32 s47, s47, 146944
    v_add_u32 v6, s47, v1
    s_xor_b32 s47, s44, 3
    s_lshl_b32 s47, s47, 12
    s_add_u32 s47, s47, 146944
    v_add_u32 v7, s47, v1
    s_waitcnt lgkmcnt(0)
    v_mov_b32 v2, v3
    s_setpc_b64 s[8:9]
L_C:
    v_mov_b64 v[64:65], 0
    v_mov_b64 v[66:67], 0
    v_bfe_u32 v5, v0, 4, 1
    v_bfe_u32 v6, v0, 2, 2
    v_lshrrev_b32 v7, 5, v0
    v_and_b32 v1, 3, v0
    v_lshlrev_b32 v1, 3, v1
    v_lshl_add_u32 v1, v7, 8, v1
    v_mul_u32_u24 v2, 4224, v5
    v_mul_u32_u24 v8, 1056, v6
    v_add3_u32 v2, v2, v8, v1
    v_mul_u32_u24 v8, 1088, v6
    v_lshl_add_u32 v3, v5, 5, v8
    v_add_u32 v3, v3, v1
    v_and_b32 v8, 15, v0
    v_mul_u32_u24 v8, 1040, v8
    v_lshl_add_u32 v4, v5, 8, v8
    v_lshl_add_u32 v4, v7, 4, v4
    s_lshl_b32 s47, s45, 6
    v_add_u32 v2, s47, v2
    s_add_u32 s47, s47, 8448
    v_add_u32 v3, s47, v3
    s_waitcnt lgkmcnt(0)
    s_lshl_b32 s47, s46, 9
    s_add_u32 s47, s47, 76800
    v_add_u32 v4, s47, v4
    v_mov_b32 v1, v4
    v_add_u32 v2, 25600, v2
    v_add_u32 v3, 25600, v3
    s_mov_b32 s48, 0xffff9c00
    s_mov_b32 s49, 0
    s_mov_b32 s50, 0
    s_lshl_b32 s53, s40, 2
    s_lshl_b32 s47, s46, 1
    s_add_u32 s53, s53, s47
    s_and_b32 s47, s41, 7
    s_lshl_b32 s47, s47, 2
    s_lshl_b32 s61, s45, 1
    s_add_u32 s47, s47, s61
    s_lshl_b32 s47, s47, 6
    s_lshl_b32 s59, s46, 4
    s_add_u32 s59, s59, s40
    s_cmp_lt_u32 s41, 8
    s_cselect_b32 s52, 10, 11
    s_cselect_b32 s61, 0x0, 0x200000
    s_cselect_b32 s58, 0x3eb8aa3b, 1.0
    s_cselect_b32 s53, s53, s59
    s_cselect_b32 s60, 1, 32
    s_add_u32 s47, s47, s53
    s_lshl_b32 s47, s47, s52
    s_add_u32 s62, s47, s61
    s_lshl_b32 s47, s60, s52
    s_add_u32 s64, s62, s47
    s_lshl_b32 s47, 64, s52
    s_add_u32 s63, s62, s47
    s_add_u32 s65, s64, s47
    s_mul_i32 s47, s45, 1280
    s_add_u32 s47, s47, 143360
    v_lshl_add_u32 v60, v0, 2, s47
    s_lshl_b32 s47, s46, 9
    s_add_u32 s47, s47, 145920
    v_and_b32 v61, 31, v0
    v_lshl_add_u32 v61, v61, 3, s47
    v_lshlrev_b32 v63, 4, v0
    v_and_b32 v72, 15, v0
    v_and_b32 v73, 16, v0
    v_cmp_eq_u32 vcc, 0, v73
    v_lshlrev_b32 v72, 4, v72
    v_add_u32 v72, 130048, v72
    v_mov_b32 v73, 16384
    v_cndmask_b32 v72, v72, v63, vcc
    v_cndmask_b32 v73, 0, v73, vcc
    s_lshl_b32 s47, s44, 12
    s_add_u32 s47, s47, 131072
    v_add_u32 v74, s47, v63
    s_lshl_b32 s66, s75, 3
    s_lshl_b32 s47, s44, 1
    s_add_u32 s66, s66, s47
    s_lshl_b32 s66, s66, 5
    s_add_u32 s66, s66, s74
    s_lshl_b32 s66, s66, 10
    s_add_u32 s66, s66, 0xd00000
    s_add_u32 s67, s66, 0x8000
    s_mov_b32 s54, 0x7e800000
    s_mov_b32 s55, 0xa800000
    s_mov_b32 s56, 0x7b800000
    s_mov_b32 s57, 0
    v_mfma_f32_32x32x16_bf16 v[96:111], v[64:67], v[64:67], 0
    v_mfma_f32_32x32x16_bf16 v[112:127], v[64:67], v[64:67], 0
    v_mfma_f32_32x32x16_bf16 v[128:143], v[64:67], v[64:67], 0
    v_mfma_f32_32x32x16_bf16 v[144:159], v[64:67], v[64:67], 0
    v_mfma_f32_32x32x16_bf16 v[160:175], v[64:67], v[64:67], 0
    v_mfma_f32_32x32x16_bf16 v[176:191], v[64:67], v[64:67], 0
    v_mfma_f32_32x32x16_bf16 v[192:207], v[64:67], v[64:67], 0
    v_mfma_f32_32x32x16_bf16 v[208:223], v[64:67], v[64:67], 0
    v_mfma_f32_32x32x16_bf16 v[224:239], v[64:67], v[64:67], 0
    v_mfma_f32_32x32x16_bf16 v[240:255], v[64:67], v[64:67], 0
    s_mul_i32 s47, s44, 12800
    s_add_u32 s47, s47, 34048
    v_and_b32 v75, 31, v0
    v_mul_u32_u24 v76, 288, v7
    v_lshl_add_u32 v75, v75, 3, v76
    v_add_u32 v75, s47, v75
    v_lshlrev_b32 v76, 2, v5
    v_add_u32 v76, v76, v7
    v_lshl_add_u32 v76, v76, 2, v6
    v_and_b32 v77, 3, v0
    v_mul_u32_u24 v77, 288, v77
    v_lshl_add_u32 v76, v76, 3, v77
    v_add_u32 v76, s47, v76
    s_and_b32 s47, s3, 3
    s_lshl_b32 s47, s47, 2
    s_add_u32 s47, s47, s45
    s_lshl_b32 s47, s47, 7
    s_add_u32 s47, s47, s59
    s_lshl_b32 s47, s47, 11
    s_add_u32 s8, s47, 0x200000
    s_add_u32 s9, s8, 524288
    s_add_u32 s10, s8, 131072
    s_add_u32 s11, s8, 655360
    s_lshl_b32 s47, s44, 10
    s_add_u32 s47, s47, 98304
    v_add_u32 v77, s47, v63
    v_subrev_u32 v62, 25600, v2
    v_mov_b32 v49, 0
    v_mov_b64 v[50:51], 0
    s_barrier
    ds_read_b128 v[20:23], v1 offset:0
    ds_read_b128 v[24:27], v1 offset:128
    ds_read_b64_tr_b16 v[12:13], v2 offset:0
    ds_read_b64_tr_b16 v[14:15], v2 offset:128
    ds_read_b64_tr_b16 v[16:17], v2 offset:32
    ds_read_b64_tr_b16 v[18:19], v2 offset:160
    ds_read_b64_tr_b16 v[8:9], v3 offset:0
    ds_read_b64_tr_b16 v[10:11], v3 offset:128
    s_waitcnt lgkmcnt(0)
    v_mfma_f32_32x32x16_bf16 v[128:143], v[12:15], v[20:23], v[128:143]
    ds_read_b128 v[40:43], v1 offset:32
    ds_read_b128 v[44:47], v1 offset:160
    ds_read_b64_tr_b16 v[32:33], v2 offset:512
    v_mfma_f32_32x32x16_bf16 v[144:159], v[12:15], v[24:27], v[144:159]
    ds_read_b64_tr_b16 v[34:35], v2 offset:640
    ds_read_b64_tr_b16 v[36:37], v2 offset:544
    ds_read_b64_tr_b16 v[38:39], v2 offset:672
    v_mfma_f32_32x32x16_bf16 v[160:175], v[16:19], v[20:23], v[160:175]
    ds_read_b64_tr_b16 v[28:29], v3 offset:512
    ds_read_b64_tr_b16 v[30:31], v3 offset:640
    v_mfma_f32_32x32x16_bf16 v[176:191], v[16:19], v[24:27], v[176:191]
    v_mfma_f32_32x32x16_bf16 v[96:111], v[8:11], v[20:23], v[96:111]
    v_mfma_f32_32x32x16_bf16 v[112:127], v[8:11], v[24:27], v[112:127]
    s_waitcnt lgkmcnt(0)
    s_barrier
    v_mfma_f32_32x32x16_bf16 v[128:143], v[32:35], v[40:43], v[128:143]
    ds_read_b128 v[20:23], v1 offset:64
    ds_read_b128 v[24:27], v1 offset:192
    ds_read_b64_tr_b16 v[12:13], v2 offset:12800
    v_mfma_f32_32x32x16_bf16 v[144:159], v[32:35], v[44:47], v[144:159]
    ds_read_b64_tr_b16 v[14:15], v2 offset:12928
    ds_read_b64_tr_b16 v[16:17], v2 offset:12832
    ds_read_b64_tr_b16 v[18:19], v2 offset:12960
    v_mfma_f32_32x32x16_bf16 v[160:175], v[36:39], v[40:43], v[160:175]
    ds_read_b64_tr_b16 v[8:9], v3 offset:12800
    ds_read_b64_tr_b16 v[10:11], v3 offset:12928
    v_mfma_f32_32x32x16_bf16 v[176:191], v[36:39], v[44:47], v[176:191]
    v_mfma_f32_32x32x16_bf16 v[96:111], v[28:31], v[40:43], v[96:111]
    v_mfma_f32_32x32x16_bf16 v[112:127], v[28:31], v[44:47], v[112:127]
    s_waitcnt lgkmcnt(0)
    v_mfma_f32_32x32x16_bf16 v[128:143], v[12:15], v[20:23], v[128:143]
    ds_read_b128 v[40:43], v1 offset:96
    ds_read_b128 v[44:47], v1 offset:224
    ds_read_b64_tr_b16 v[32:33], v2 offset:13312
    v_mfma_f32_32x32x16_bf16 v[144:159], v[12:15], v[24:27], v[144:159]
    ds_read_b64_tr_b16 v[34:35], v2 offset:13440
    ds_read_b64_tr_b16 v[36:37], v2 offset:13344
    ds_read_b64_tr_b16 v[38:39], v2 offset:13472
    v_mfma_f32_32x32x16_bf16 v[160:175], v[16:19], v[20:23], v[160:175]
    ds_read_b64_tr_b16 v[28:29], v3 offset:13312
    ds_read_b64_tr_b16 v[30:31], v3 offset:13440
    v_mfma_f32_32x32x16_bf16 v[176:191], v[16:19], v[24:27], v[176:191]
    v_mfma_f32_32x32x16_bf16 v[96:111], v[8:11], v[20:23], v[96:111]
    v_mfma_f32_32x32x16_bf16 v[112:127], v[8:11], v[24:27], v[112:127]
    s_waitcnt lgkmcnt(0)
    v_mfma_f32_32x32x16_bf16 v[128:143], v[32:35], v[40:43], v[128:143]
    v_mfma_f32_32x32x16_bf16 v[144:159], v[32:35], v[44:47], v[144:159]
    v_mfma_f32_32x32x16_bf16 v[160:175], v[36:39], v[40:43], v[160:175]
    v_mfma_f32_32x32x16_bf16 v[176:191], v[36:39], v[44:47], v[176:191]
    v_mfma_f32_32x32x16_bf16 v[96:111], v[28:31], v[40:43], v[96:111]
    v_mfma_f32_32x32x16_bf16 v[112:127], v[28:31], v[44:47], v[112:127]
    s_barrier
    ds_read_b128 v[20:23], v4 offset:0
    ds_read_b128 v[24:27], v4 offset:128
    ds_read_b64_tr_b16 v[12:13], v62 offset:51200
    ds_read_b64_tr_b16 v[14:15], v62 offset:51328
    ds_read_b64_tr_b16 v[16:17], v62 offset:51232
    ds_read_b64_tr_b16 v[18:19], v62 offset:51360
    s_waitcnt lgkmcnt(0)
    v_mfma_f32_32x32x16_bf16 v[192:207], v[12:15], v[20:23], v[192:207]
    ds_read_b128 v[40:43], v4 offset:32
    ds_read_b128 v[44:47], v4 offset:160
    ds_read_b64_tr_b16 v[32:33], v62 offset:51712
    v_mfma_f32_32x32x16_bf16 v[208:223], v[12:15], v[24:27], v[208:223]
    ds_read_b64_tr_b16 v[34:35], v62 offset:51840
    ds_read_b64_tr_b16 v[36:37], v62 offset:51744
    ds_read_b64_tr_b16 v[38:39], v62 offset:51872
    v_mfma_f32_32x32x16_bf16 v[224:239], v[16:19], v[20:23], v[224:239]
    v_mfma_f32_32x32x16_bf16 v[240:255], v[16:19], v[24:27], v[240:255]
    s_waitcnt lgkmcnt(0)
    v_mfma_f32_32x32x16_bf16 v[192:207], v[32:35], v[40:43], v[192:207]
    ds_read_b128 v[20:23], v4 offset:64
    ds_read_b128 v[24:27], v4 offset:192
    ds_read_b64_tr_b16 v[12:13], v62 offset:64000
    v_mfma_f32_32x32x16_bf16 v[208:223], v[32:35], v[44:47], v[208:223]
    ds_read_b64_tr_b16 v[14:15], v62 offset:64128
    ds_read_b64_tr_b16 v[16:17], v62 offset:64032
    ds_read_b64_tr_b16 v[18:19], v62 offset:64160
    v_mfma_f32_32x32x16_bf16 v[224:239], v[36:39], v[40:43], v[224:239]
    v_mfma_f32_32x32x16_bf16 v[240:255], v[36:39], v[44:47], v[240:255]
    s_waitcnt lgkmcnt(0)
    v_mfma_f32_32x32x16_bf16 v[192:207], v[12:15], v[20:23], v[192:207]
    ds_read_b128 v[40:43], v4 offset:96
    ds_read_b128 v[44:47], v4 offset:224
    ds_read_b64_tr_b16 v[32:33], v62 offset:64512
    v_mfma_f32_32x32x16_bf16 v[208:223], v[12:15], v[24:27], v[208:223]
    ds_read_b64_tr_b16 v[34:35], v62 offset:64640
    ds_read_b64_tr_b16 v[36:37], v62 offset:64544
    ds_read_b64_tr_b16 v[38:39], v62 offset:64672
    v_mfma_f32_32x32x16_bf16 v[224:239], v[16:19], v[20:23], v[224:239]
    v_mfma_f32_32x32x16_bf16 v[240:255], v[16:19], v[24:27], v[240:255]
    s_waitcnt lgkmcnt(0)
    v_mfma_f32_32x32x16_bf16 v[192:207], v[32:35], v[40:43], v[192:207]
    v_mfma_f32_32x32x16_bf16 v[208:223], v[32:35], v[44:47], v[208:223]
    v_mfma_f32_32x32x16_bf16 v[224:239], v[36:39], v[40:43], v[224:239]
    v_mfma_f32_32x32x16_bf16 v[240:255], v[36:39], v[44:47], v[240:255]
    v_add_u32 v2, s48, v2
    v_add_u32 v3, s48, v3
    s_mov_b32 s49, 16640
    s_sub_u32 s48, 0, s48
    v_add_u32 v1, s49, v4
    s_mov_b32 s50, 1
    s_barrier
    ds_read_b128 v[20:23], v1 offset:0
    ds_read_b128 v[24:27], v1 offset:128
    ds_read_b64_tr_b16 v[12:13], v2 offset:0
    ds_read_b64_tr_b16 v[14:15], v2 offset:128
    ds_read_b64_tr_b16 v[16:17], v2 offset:32
    ds_read_b64_tr_b16 v[18:19], v2 offset:160
    ds_read_b64_tr_b16 v[8:9], v3 offset:0
    ds_read_b64_tr_b16 v[10:11], v3 offset:128
LC_loopA:
    s_waitcnt lgkmcnt(0)
    v_mfma_f32_32x32x16_bf16 v[128:143], v[12:15], v[20:23], v[128:143]
    ds_read_b128 v[40:43], v1 offset:32
    ds_read_b128 v[44:47], v1 offset:160
    ds_read_b64_tr_b16 v[32:33], v2 offset:512
    v_mfma_f32_32x32x16_bf16 v[144:159], v[12:15], v[24:27], v[144:159]
    ds_read_b64_tr_b16 v[34:35], v2 offset:640
    ds_read_b64_tr_b16 v[36:37], v2 offset:544
    ds_read_b64_tr_b16 v[38:39], v2 offset:672
    v_mfma_f32_32x32x16_bf16 v[160:175], v[16:19], v[20:23], v[160:175]
    ds_read_b64_tr_b16 v[28:29], v3 offset:512
    ds_read_b64_tr_b16 v[30:31], v3 offset:640
    v_mfma_f32_32x32x16_bf16 v[176:191], v[16:19], v[24:27], v[176:191]
    v_mfma_f32_32x32x16_bf16 v[96:111], v[8:11], v[20:23], v[96:111]
    v_mfma_f32_32x32x16_bf16 v[112:127], v[8:11], v[24:27], v[112:127]
    s_waitcnt lgkmcnt(0)
    s_barrier
    v_mfma_f32_32x32x16_bf16 v[128:143], v[32:35], v[40:43], v[128:143]
    ds_read_b128 v[20:23], v1 offset:64
    ds_read_b128 v[24:27], v1 offset:192
    ds_read_b64_tr_b16 v[12:13], v2 offset:12800
    v_mfma_f32_32x32x16_bf16 v[144:159], v[32:35], v[44:47], v[144:159]
    ds_read_b64_tr_b16 v[14:15], v2 offset:12928
    ds_read_b64_tr_b16 v[16:17], v2 offset:12832
    ds_read_b64_tr_b16 v[18:19], v2 offset:12960
    v_mfma_f32_32x32x16_bf16 v[160:175], v[36:39], v[40:43], v[160:175]
    ds_read_b64_tr_b16 v[8:9], v3 offset:12800
    ds_read_b64_tr_b16 v[10:11], v3 offset:12928
    v_mfma_f32_32x32x16_bf16 v[176:191], v[36:39], v[44:47], v[176:191]
    v_mfma_f32_32x32x16_bf16 v[96:111], v[28:31], v[40:43], v[96:111]
    v_mfma_f32_32x32x16_bf16 v[112:127], v[28:31], v[44:47], v[112:127]
    s_waitcnt lgkmcnt(0)
    v_mfma_f32_32x32x16_bf16 v[128:143], v[12:15], v[20:23], v[128:143]
    ds_read_b128 v[40:43], v1 offset:96
    ds_read_b128 v[44:47], v1 offset:224
    ds_read_b64_tr_b16 v[32:33], v2 offset:13312
    v_mfma_f32_32x32x16_bf16 v[144:159], v[12:15], v[24:27], v[144:159]
    ds_read_b64_tr_b16 v[34:35], v2 offset:13440
    ds_read_b64_tr_b16 v[36:37], v2 offset:13344
    ds_read_b64_tr_b16 v[38:39], v2 offset:13472
    v_mfma_f32_32x32x16_bf16 v[160:175], v[16:19], v[20:23], v[160:175]
    ds_read_b64_tr_b16 v[28:29], v3 offset:13312
    ds_read_b64_tr_b16 v[30:31], v3 offset:13440
    v_mfma_f32_32x32x16_bf16 v[176:191], v[16:19], v[24:27], v[176:191]
    v_mfma_f32_32x32x16_bf16 v[96:111], v[8:11], v[20:23], v[96:111]
    v_mfma_f32_32x32x16_bf16 v[112:127], v[8:11], v[24:27], v[112:127]
    v_add_u32 v2, s48, v2
    v_add_u32 v3, s48, v3
    s_add_u32 s49, s49, 16640
    s_cmp_ge_u32 s49, 66560
    s_cselect_b32 s49, 0, s49
    s_sub_u32 s48, 0, s48
    v_add_u32 v1, s49, v4
    s_waitcnt lgkmcnt(0)
    s_barrier
    v_mfma_f32_32x32x16_bf16 v[128:143], v[32:35], v[40:43], v[128:143]
    ds_read_b128 v[20:23], v1 offset:0
    ds_read_b128 v[24:27], v1 offset:128
    ds_read_b64_tr_b16 v[12:13], v2 offset:0
    v_mfma_f32_32x32x16_bf16 v[144:159], v[32:35], v[44:47], v[144:159]
    ds_read_b64_tr_b16 v[14:15], v2 offset:128
    ds_read_b64_tr_b16 v[16:17], v2 offset:32
    ds_read_b64_tr_b16 v[18:19], v2 offset:160
    v_mfma_f32_32x32x16_bf16 v[160:175], v[36:39], v[40:43], v[160:175]
    ds_read_b64_tr_b16 v[8:9], v3 offset:0
    ds_read_b64_tr_b16 v[10:11], v3 offset:128
    v_mfma_f32_32x32x16_bf16 v[176:191], v[36:39], v[44:47], v[176:191]
    v_mfma_f32_32x32x16_bf16 v[96:111], v[28:31], v[40:43], v[96:111]
    s_add_u32 s50, s50, 1
    v_mfma_f32_32x32x16_bf16 v[112:127], v[28:31], v[44:47], v[112:127]
    s_cmp_lt_u32 s50, 8
    s_cbranch_scc1 LC_loopA
    s_waitcnt lgkmcnt(0)
    ds_read_b64 v[68:69], v61
    ds_read_b64 v[70:71], v61 offset:256
    ds_read_b32 v8, v60 offset:0
    ds_read_b32 v12, v60 offset:256
    ds_read_b32 v16, v60 offset:512
    ds_read_b32 v20, v60 offset:768
    ds_read_b32 v24, v60 offset:1024
    v_mov_b32 v9, 0
    v_mov_b64 v[10:11], 0
    v_mov_b32 v13, 0
    v_mov_b64 v[14:15], 0
    v_mov_b32 v17, 0
    v_mov_b64 v[18:19], 0
    v_mov_b32 v21, 0
    v_mov_b64 v[22:23], 0
    v_mov_b32 v25, 0
    v_mov_b64 v[26:27], 0
    s_waitcnt lgkmcnt(5)
    v_mov_b32 v64, v68
    v_mov_b32 v48, v70
    v_rcp_f32 v84, v69
    v_rcp_f32 v92, v71
    s_waitcnt lgkmcnt(0)
    v_mfma_f32_32x32x16_bf16 v[96:111], v[8:11], v[64:67], v[96:111]
    ds_read_b128 v[40:43], v4 offset:49920
    ds_read_b128 v[44:47], v4 offset:50048
    ds_read_b64_tr_b16 v[32:33], v62 offset:51200
    ds_read_b64_tr_b16 v[34:35], v62 offset:51328
    ds_read_b64_tr_b16 v[36:37], v62 offset:51232
    ds_read_b64_tr_b16 v[38:39], v62 offset:51360
    v_mfma_f32_32x32x16_bf16 v[112:127], v[8:11], v[48:51], v[112:127]
    v_mul_f32 v83, s58, v84
    v_mul_f32 v82, v69, v69
    v_mul_f32 v81, 0xc0135761, v84
    v_mul_f32 v80, v84, v84
    v_mul_f32 v80, v80, v84
    v_mfma_f32_32x32x16_bf16 v[128:143], v[12:15], v[64:67], v[128:143]
    v_mul_f32 v80, 0xbdd2d3e8, v80
    v_mul_f32 v85, 0x45800000, v84
    v_mul_f32 v91, s58, v92
    v_mul_f32 v90, v71, v71
    v_mul_f32 v89, 0xc0135761, v92
    v_mfma_f32_32x32x16_bf16 v[144:159], v[12:15], v[48:51], v[144:159]
    v_mul_f32 v88, v92, v92
    v_mul_f32 v88, v88, v92
    v_mul_f32 v88, 0xbdd2d3e8, v88
    v_mul_f32 v93, 0x45800000, v92
    v_mul_f32 v96, v83, v96
    v_mfma_f32_32x32x16_bf16 v[160:175], v[16:19], v[64:67], v[160:175]
    v_mul_f32 v97, v83, v97
    v_mul_f32 v98, v83, v98
    v_mul_f32 v99, v83, v99
    v_mul_f32 v100, v83, v100
    v_mul_f32 v101, v83, v101
    v_mfma_f32_32x32x16_bf16 v[176:191], v[16:19], v[48:51], v[176:191]
    v_mul_f32 v102, v83, v102
    v_mul_f32 v103, v83, v103
    v_cvt_pk_bf16_f32 v96, v96, v97
    v_cvt_pk_bf16_f32 v97, v98, v99
    v_cvt_pk_bf16_f32 v98, v100, v101
    v_mfma_f32_32x32x16_bf16 v[192:207], v[20:23], v[64:67], v[192:207]
    v_cvt_pk_bf16_f32 v99, v102, v103
    buffer_store_dwordx4 v[96:99], v63, s[32:35], s62 offen sc1
    v_mul_f32 v104, v83, v104
    v_mul_f32 v105, v83, v105
    v_mul_f32 v106, v83, v106
    v_mfma_f32_32x32x16_bf16 v[208:223], v[20:23], v[48:51], v[208:223]
    v_mul_f32 v107, v83, v107
    v_mul_f32 v108, v83, v108
    v_mul_f32 v109, v83, v109
    v_mul_f32 v110, v83, v110
    v_mul_f32 v111, v83, v111
    v_mfma_f32_32x32x16_bf16 v[224:239], v[24:27], v[64:67], v[224:239]
    v_cvt_pk_bf16_f32 v104, v104, v105
    v_cvt_pk_bf16_f32 v105, v106, v107
    v_cvt_pk_bf16_f32 v106, v108, v109
    v_cvt_pk_bf16_f32 v107, v110, v111
    buffer_store_dwordx4 v[104:107], v63, s[32:35], s63 offen sc1
    v_mfma_f32_32x32x16_bf16 v[240:255], v[24:27], v[48:51], v[240:255]
    s_cmp_eq_u32 s71, 3
    s_cbranch_scc1 LC_Bv
    s_waitcnt lgkmcnt(0)
    v_mfma_f32_32x32x16_bf16 v[192:207], v[32:35], v[40:43], v[192:207]
    ds_read_b128 v[20:23], v4 offset:49952
    ds_read_b128 v[24:27], v4 offset:50080
    ds_read_b64_tr_b16 v[12:13], v62 offset:51712
    v_mul_f32 v112, v91, v112
    v_mul_f32 v113, v91, v113
    v_mfma_f32_32x32x16_bf16 v[208:223], v[32:35], v[44:47], v[208:223]
    ds_read_b64_tr_b16 v[14:15], v62 offset:51840
    ds_read_b64_tr_b16 v[16:17], v62 offset:51744
    ds_read_b64_tr_b16 v[18:19], v62 offset:51872
    v_mul_f32 v114, v91, v114
    v_mul_f32 v115, v91, v115
    v_mfma_f32_32x32x16_bf16 v[224:239], v[36:39], v[40:43], v[224:239]
    v_mul_f32 v116, v91, v116
    v_mul_f32 v117, v91, v117
    v_mul_f32 v118, v91, v118
    v_mul_f32 v119, v91, v119
    v_cvt_pk_bf16_f32 v112, v112, v113
    v_mfma_f32_32x32x16_bf16 v[240:255], v[36:39], v[44:47], v[240:255]
    v_cvt_pk_bf16_f32 v113, v114, v115
    v_cvt_pk_bf16_f32 v114, v116, v117
    v_cvt_pk_bf16_f32 v115, v118, v119
    v_mul_f32 v120, v91, v120
    v_mul_f32 v121, v91, v121
    s_waitcnt lgkmcnt(0)
    s_barrier
    v_mfma_f32_32x32x16_bf16 v[192:207], v[12:15], v[20:23], v[192:207]
    ds_read_b128 v[40:43], v4 offset:49984
    ds_read_b128 v[44:47], v4 offset:50112
    ds_read_b64_tr_b16 v[32:33], v62 offset:64000
    v_mul_f32 v122, v91, v122
    v_mul_f32 v123, v91, v123
    v_mfma_f32_32x32x16_bf16 v[208:223], v[12:15], v[24:27], v[208:223]
    ds_read_b64_tr_b16 v[34:35], v62 offset:64128
    ds_read_b64_tr_b16 v[36:37], v62 offset:64032
    ds_read_b64_tr_b16 v[38:39], v62 offset:64160
    v_mul_f32 v124, v91, v124
    v_mul_f32 v125, v91, v125
    v_mfma_f32_32x32x16_bf16 v[224:239], v[16:19], v[20:23], v[224:239]
    v_mul_f32 v126, v91, v126
    v_mul_f32 v127, v91, v127
    v_cvt_pk_bf16_f32 v120, v120, v121
    v_cvt_pk_bf16_f32 v121, v122, v123
    v_cvt_pk_bf16_f32 v122, v124, v125
    v_mfma_f32_32x32x16_bf16 v[240:255], v[16:19], v[24:27], v[240:255]
    buffer_store_dwordx4 v[112:115], v63, s[32:35], s64 offen sc1
    v_cvt_pk_bf16_f32 v123, v126, v127
    v_mul_f32 v52, v128, v128
    s_waitcnt lgkmcnt(0)
    v_mfma_f32_32x32x16_bf16 v[192:207], v[32:35], v[40:43], v[192:207]
    ds_read_b128 v[20:23], v4 offset:50016
    ds_read_b128 v[24:27], v4 offset:50144
    ds_read_b64_tr_b16 v[12:13], v62 offset:64512
    v_mul_f32 v53, v129, v129
    v_mul_f32 v54, v130, v130
    v_mfma_f32_32x32x16_bf16 v[208:223], v[32:35], v[44:47], v[208:223]
    ds_read_b64_tr_b16 v[14:15], v62 offset:64640
    ds_read_b64_tr_b16 v[16:17], v62 offset:64544
    ds_read_b64_tr_b16 v[18:19], v62 offset:64672
    v_mul_f32 v55, v131, v131
    v_fma_f32 v52, v52, v80, v81
    v_mfma_f32_32x32x16_bf16 v[224:239], v[36:39], v[40:43], v[224:239]
    v_fma_f32 v53, v53, v80, v81
    v_fma_f32 v54, v54, v80, v81
    v_fma_f32 v55, v55, v80, v81
    v_mul_f32 v52, v52, v128
    v_mul_f32 v53, v53, v129
    v_mfma_f32_32x32x16_bf16 v[240:255], v[36:39], v[44:47], v[240:255]
    buffer_store_dwordx4 v[120:123], v63, s[32:35], s65 offen sc1
    v_mul_f32 v54, v54, v130
    v_mul_f32 v55, v55, v131
    s_waitcnt lgkmcnt(0)
    s_barrier
    v_mfma_f32_32x32x16_bf16 v[192:207], v[12:15], v[20:23], v[192:207]
    ds_read_b128 v[40:43], v4 offset:33280
    ds_read_b128 v[44:47], v4 offset:33408
    ds_read_b64_tr_b16 v[32:33], v62 offset:25600
    v_exp_f32 v52, v52
    v_mfma_f32_32x32x16_bf16 v[208:223], v[12:15], v[24:27], v[208:223]
    ds_read_b64_tr_b16 v[34:35], v62 offset:25728
    ds_read_b64_tr_b16 v[36:37], v62 offset:25632
    ds_read_b64_tr_b16 v[38:39], v62 offset:25760
    v_exp_f32 v53, v53
    v_mfma_f32_32x32x16_bf16 v[224:239], v[16:19], v[20:23], v[224:239]
    v_exp_f32 v54, v54
    v_exp_f32 v55, v55
    v_mul_f32 v128, v128, v136
    v_mfma_f32_32x32x16_bf16 v[240:255], v[16:19], v[24:27], v[240:255]
    v_mul_f32 v129, v129, v137
    v_mul_f32 v130, v130, v138
    v_mul_f32 v131, v131, v139
    v_fma_f32 v52, v52, v82, v82
    v_fma_f32 v53, v53, v82, v82
    s_waitcnt lgkmcnt(0)
    v_mfma_f32_32x32x16_bf16 v[192:207], v[32:35], v[40:43], v[192:207]
    ds_read_b128 v[20:23], v4 offset:33312
    ds_read_b128 v[24:27], v4 offset:33440
    ds_read_b64_tr_b16 v[12:13], v62 offset:26112
    v_fma_f32 v54, v54, v82, v82
    v_fma_f32 v55, v55, v82, v82
    v_mfma_f32_32x32x16_bf16 v[208:223], v[32:35], v[44:47], v[208:223]
    ds_read_b64_tr_b16 v[14:15], v62 offset:26240
    ds_read_b64_tr_b16 v[16:17], v62 offset:26144
    ds_read_b64_tr_b16 v[18:19], v62 offset:26272
    v_rcp_f32 v52, v52
    v_mfma_f32_32x32x16_bf16 v[224:239], v[36:39], v[40:43], v[224:239]
    v_rcp_f32 v53, v53
    v_rcp_f32 v54, v54
    v_mfma_f32_32x32x16_bf16 v[240:255], v[36:39], v[44:47], v[240:255]
    v_rcp_f32 v55, v55
    v_mul_f32 v128, v128, v52
    v_mul_f32 v129, v129, v53
    v_mul_f32 v130, v130, v54
    s_waitcnt lgkmcnt(0)
    s_barrier
    v_mfma_f32_32x32x16_bf16 v[192:207], v[12:15], v[20:23], v[192:207]
    ds_read_b128 v[40:43], v4 offset:33344
    ds_read_b128 v[44:47], v4 offset:33472
    ds_read_b64_tr_b16 v[32:33], v62 offset:38400
    v_mul_f32 v131, v131, v55
    v_cvt_pk_bf16_f32 v136, v128, v129
    v_mfma_f32_32x32x16_bf16 v[208:223], v[12:15], v[24:27], v[208:223]
    ds_read_b64_tr_b16 v[34:35], v62 offset:38528
    ds_read_b64_tr_b16 v[36:37], v62 offset:38432
    ds_read_b64_tr_b16 v[38:39], v62 offset:38560
    v_cvt_pk_bf16_f32 v137, v130, v131
    v_mul_f32 v56, v132, v132
    v_mfma_f32_32x32x16_bf16 v[224:239], v[16:19], v[20:23], v[224:239]
    v_mul_f32 v57, v133, v133
    v_mul_f32 v58, v134, v134
    v_mul_f32 v59, v135, v135
    v_fma_f32 v56, v56, v80, v81
    v_fma_f32 v57, v57, v80, v81
    v_mfma_f32_32x32x16_bf16 v[240:255], v[16:19], v[24:27], v[240:255]
    v_fma_f32 v58, v58, v80, v81
    v_fma_f32 v59, v59, v80, v81
    v_mul_f32 v56, v56, v132
    v_mul_f32 v57, v57, v133
    v_mul_f32 v58, v58, v134
    s_waitcnt lgkmcnt(0)
    v_mfma_f32_32x32x16_bf16 v[192:207], v[32:35], v[40:43], v[192:207]
    ds_read_b128 v[20:23], v4 offset:33376
    ds_read_b128 v[24:27], v4 offset:33504
    ds_read_b64_tr_b16 v[12:13], v62 offset:38912
    v_mul_f32 v59, v59, v135
    v_mfma_f32_32x32x16_bf16 v[208:223], v[32:35], v[44:47], v[208:223]
    ds_read_b64_tr_b16 v[14:15], v62 offset:39040
    ds_read_b64_tr_b16 v[16:17], v62 offset:38944
    ds_read_b64_tr_b16 v[18:19], v62 offset:39072
    v_exp_f32 v56, v56
    v_mfma_f32_32x32x16_bf16 v[224:239], v[36:39], v[40:43], v[224:239]
    v_exp_f32 v57, v57
    v_exp_f32 v58, v58
    v_mfma_f32_32x32x16_bf16 v[240:255], v[36:39], v[44:47], v[240:255]
    v_exp_f32 v59, v59
    v_mul_f32 v132, v132, v140
    v_mul_f32 v133, v133, v141
    v_mul_f32 v134, v134, v142
    s_waitcnt lgkmcnt(0)
    s_barrier
    v_mfma_f32_32x32x16_bf16 v[192:207], v[12:15], v[20:23], v[192:207]
    ds_read_b128 v[40:43], v4 offset:16640
    ds_read_b128 v[44:47], v4 offset:16768
    ds_read_b64_tr_b16 v[32:33], v62 offset:0
    v_mul_f32 v135, v135, v143
    v_fma_f32 v56, v56, v82, v82
    v_mfma_f32_32x32x16_bf16 v[208:223], v[12:15], v[24:27], v[208:223]
    ds_read_b64_tr_b16 v[34:35], v62 offset:128
    ds_read_b64_tr_b16 v[36:37], v62 offset:32
    ds_read_b64_tr_b16 v[38:39], v62 offset:160
    v_fma_f32 v57, v57, v82, v82
    v_fma_f32 v58, v58, v82, v82
    v_mfma_f32_32x32x16_bf16 v[224:239], v[16:19], v[20:23], v[224:239]
    v_fma_f32 v59, v59, v82, v82
    v_rcp_f32 v56, v56
    v_rcp_f32 v57, v57
    v_mfma_f32_32x32x16_bf16 v[240:255], v[16:19], v[24:27], v[240:255]
    v_rcp_f32 v58, v58
    v_rcp_f32 v59, v59
    v_mul_f32 v132, v132, v56
    s_waitcnt lgkmcnt(0)
    v_mfma_f32_32x32x16_bf16 v[192:207], v[32:35], v[40:43], v[192:207]
    ds_read_b128 v[20:23], v4 offset:16672
    ds_read_b128 v[24:27], v4 offset:16800
    ds_read_b64_tr_b16 v[12:13], v62 offset:512
    v_mul_f32 v133, v133, v57
    v_mul_f32 v134, v134, v58
    v_mfma_f32_32x32x16_bf16 v[208:223], v[32:35], v[44:47], v[208:223]
    ds_read_b64_tr_b16 v[14:15], v62 offset:640
    ds_read_b64_tr_b16 v[16:17], v62 offset:544
    ds_read_b64_tr_b16 v[18:19], v62 offset:672
    v_mul_f32 v135, v135, v59
    v_cvt_pk_bf16_f32 v138, v132, v133
    v_mfma_f32_32x32x16_bf16 v[224:239], v[36:39], v[40:43], v[224:239]
    v_cvt_pk_bf16_f32 v139, v134, v135
    v_mul_f32 v52, v160, v160
    v_mul_f32 v53, v161, v161
    v_mul_f32 v54, v162, v162
    v_mul_f32 v55, v163, v163
    v_mfma_f32_32x32x16_bf16 v[240:255], v[36:39], v[44:47], v[240:255]
    v_fma_f32 v52, v52, v80, v81
    v_fma_f32 v53, v53, v80, v81
    v_fma_f32 v54, v54, v80, v81
    v_fma_f32 v55, v55, v80, v81
    v_mul_f32 v52, v52, v160
    s_waitcnt lgkmcnt(0) vmcnt(0)
    s_barrier
    v_mfma_f32_32x32x16_bf16 v[192:207], v[12:15], v[20:23], v[192:207]
    ds_read_b128 v[40:43], v4 offset:16704
    ds_read_b128 v[44:47], v4 offset:16832
    ds_read_b64_tr_b16 v[32:33], v62 offset:12800
    v_mul_f32 v53, v53, v161
    v_mul_f32 v54, v54, v162
    v_mfma_f32_32x32x16_bf16 v[208:223], v[12:15], v[24:27], v[208:223]
    ds_read_b64_tr_b16 v[34:35], v62 offset:12928
    ds_read_b64_tr_b16 v[36:37], v62 offset:12832
    ds_read_b64_tr_b16 v[38:39], v62 offset:12960
    v_mul_f32 v55, v55, v163
    v_mfma_f32_32x32x16_bf16 v[224:239], v[16:19], v[20:23], v[224:239]
    v_exp_f32 v52, v52
    v_exp_f32 v53, v53
    v_mfma_f32_32x32x16_bf16 v[240:255], v[16:19], v[24:27], v[240:255]
    v_exp_f32 v54, v54
    v_exp_f32 v55, v55
    v_mul_f32 v160, v160, v168
    s_waitcnt lgkmcnt(0)
    v_mfma_f32_32x32x16_bf16 v[192:207], v[32:35], v[40:43], v[192:207]
    ds_read_b128 v[20:23], v4 offset:16736
    ds_read_b128 v[24:27], v4 offset:16864
    ds_read_b64_tr_b16 v[12:13], v62 offset:13312
    v_mul_f32 v161, v161, v169
    v_mul_f32 v162, v162, v170
    v_mfma_f32_32x32x16_bf16 v[208:223], v[32:35], v[44:47], v[208:223]
    ds_read_b64_tr_b16 v[14:15], v62 offset:13440
    ds_read_b64_tr_b16 v[16:17], v62 offset:13344
    ds_read_b64_tr_b16 v[18:19], v62 offset:13472
    v_mul_f32 v163, v163, v171
    v_fma_f32 v52, v52, v82, v82
    v_mfma_f32_32x32x16_bf16 v[224:239], v[36:39], v[40:43], v[224:239]
    v_fma_f32 v53, v53, v82, v82
    v_fma_f32 v54, v54, v82, v82
    v_fma_f32 v55, v55, v82, v82
    v_rcp_f32 v52, v52
    v_mfma_f32_32x32x16_bf16 v[240:255], v[36:39], v[44:47], v[240:255]
    v_rcp_f32 v53, v53
    v_rcp_f32 v54, v54
    s_waitcnt lgkmcnt(0)
    s_barrier
    v_mfma_f32_32x32x16_bf16 v[192:207], v[12:15], v[20:23], v[192:207]
    ds_read_b128 v[40:43], v4 offset:0
    ds_read_b128 v[44:47], v4 offset:128
    ds_read_b64_tr_b16 v[32:33], v62 offset:51200
    v_rcp_f32 v55, v55
    v_mfma_f32_32x32x16_bf16 v[208:223], v[12:15], v[24:27], v[208:223]
    ds_read_b64_tr_b16 v[34:35], v62 offset:51328
    ds_read_b64_tr_b16 v[36:37], v62 offset:51232
    ds_read_b64_tr_b16 v[38:39], v62 offset:51360
    v_mul_f32 v160, v160, v52
    v_mul_f32 v161, v161, v53
    v_mfma_f32_32x32x16_bf16 v[224:239], v[16:19], v[20:23], v[224:239]
    v_mul_f32 v162, v162, v54
    v_mul_f32 v163, v163, v55
    v_cvt_pk_bf16_f32 v168, v160, v161
    v_cvt_pk_bf16_f32 v169, v162, v163
    v_mul_f32 v56, v164, v164
    v_mfma_f32_32x32x16_bf16 v[240:255], v[16:19], v[24:27], v[240:255]
    v_mul_f32 v57, v165, v165
    v_mul_f32 v58, v166, v166
    v_mul_f32 v59, v167, v167
    v_fma_f32 v56, v56, v80, v81
    v_fma_f32 v57, v57, v80, v81
    s_waitcnt lgkmcnt(0)
    v_mfma_f32_32x32x16_bf16 v[192:207], v[32:35], v[40:43], v[192:207]
    ds_read_b128 v[20:23], v4 offset:32
    ds_read_b128 v[24:27], v4 offset:160
    ds_read_b64_tr_b16 v[12:13], v62 offset:51712
    v_fma_f32 v58, v58, v80, v81
    v_fma_f32 v59, v59, v80, v81
    v_mfma_f32_32x32x16_bf16 v[208:223], v[32:35], v[44:47], v[208:223]
    ds_read_b64_tr_b16 v[14:15], v62 offset:51840
    ds_read_b64_tr_b16 v[16:17], v62 offset:51744
    ds_read_b64_tr_b16 v[18:19], v62 offset:51872
    v_mul_f32 v56, v56, v164
    v_mul_f32 v57, v57, v165
    v_mfma_f32_32x32x16_bf16 v[224:239], v[36:39], v[40:43], v[224:239]
    v_mul_f32 v58, v58, v166
    v_mul_f32 v59, v59, v167
    v_exp_f32 v56, v56
    v_mfma_f32_32x32x16_bf16 v[240:255], v[36:39], v[44:47], v[240:255]
    v_exp_f32 v57, v57
    v_exp_f32 v58, v58
    s_waitcnt lgkmcnt(0)
    s_barrier
    v_mfma_f32_32x32x16_bf16 v[192:207], v[12:15], v[20:23], v[192:207]
    ds_read_b128 v[40:43], v4 offset:64
    ds_read_b128 v[44:47], v4 offset:192
    ds_read_b64_tr_b16 v[32:33], v62 offset:64000
    v_exp_f32 v59, v59
    v_mfma_f32_32x32x16_bf16 v[208:223], v[12:15], v[24:27], v[208:223]
    ds_read_b64_tr_b16 v[34:35], v62 offset:64128
    ds_read_b64_tr_b16 v[36:37], v62 offset:64032
    ds_read_b64_tr_b16 v[38:39], v62 offset:64160
    v_mul_f32 v164, v164, v172
    v_mul_f32 v165, v165, v173
    v_mfma_f32_32x32x16_bf16 v[224:239], v[16:19], v[20:23], v[224:239]
    v_mul_f32 v166, v166, v174
    v_mul_f32 v167, v167, v175
    v_fma_f32 v56, v56, v82, v82
    v_fma_f32 v57, v57, v82, v82
    v_fma_f32 v58, v58, v82, v82
    v_mfma_f32_32x32x16_bf16 v[240:255], v[16:19], v[24:27], v[240:255]
    v_fma_f32 v59, v59, v82, v82
    v_rcp_f32 v56, v56
    v_rcp_f32 v57, v57
    s_waitcnt lgkmcnt(0)
    v_mfma_f32_32x32x16_bf16 v[192:207], v[32:35], v[40:43], v[192:207]
    ds_read_b128 v[20:23], v4 offset:96
    ds_read_b128 v[24:27], v4 offset:224
    ds_read_b64_tr_b16 v[12:13], v62 offset:64512
    v_rcp_f32 v58, v58
    v_mfma_f32_32x32x16_bf16 v[208:223], v[32:35], v[44:47], v[208:223]
    ds_read_b64_tr_b16 v[14:15], v62 offset:64640
    ds_read_b64_tr_b16 v[16:17], v62 offset:64544
    ds_read_b64_tr_b16 v[18:19], v62 offset:64672
    v_rcp_f32 v59, v59
    v_mfma_f32_32x32x16_bf16 v[224:239], v[36:39], v[40:43], v[224:239]
    v_mul_f32 v164, v164, v56
    v_mul_f32 v165, v165, v57
    v_mul_f32 v166, v166, v58
    v_mul_f32 v167, v167, v59
    v_cvt_pk_bf16_f32 v170, v164, v165
    v_mfma_f32_32x32x16_bf16 v[240:255], v[36:39], v[44:47], v[240:255]
    v_cvt_pk_bf16_f32 v171, v166, v167
    v_mul_f32 v52, v144, v144
    v_mul_f32 v53, v145, v145
    v_mul_f32 v54, v146, v146
    v_mul_f32 v55, v147, v147
    s_waitcnt lgkmcnt(0)
    s_barrier
    v_mfma_f32_32x32x16_bf16 v[192:207], v[12:15], v[20:23], v[192:207]
    ds_read_b128 v[40:43], v4 offset:49920
    ds_read_b128 v[44:47], v4 offset:50048
    ds_read_b64_tr_b16 v[32:33], v62 offset:25600
    v_fma_f32 v52, v52, v88, v89
    v_fma_f32 v53, v53, v88, v89
    v_mfma_f32_32x32x16_bf16 v[208:223], v[12:15], v[24:27], v[208:223]
    ds_read_b64_tr_b16 v[34:35], v62 offset:25728
    ds_read_b64_tr_b16 v[36:37], v62 offset:25632
    ds_read_b64_tr_b16 v[38:39], v62 offset:25760
    v_fma_f32 v54, v54, v88, v89
    v_fma_f32 v55, v55, v88, v89
    v_mfma_f32_32x32x16_bf16 v[224:239], v[16:19], v[20:23], v[224:239]
    v_mul_f32 v52, v52, v144
    v_mul_f32 v53, v53, v145
    v_mul_f32 v54, v54, v146
    v_mul_f32 v55, v55, v147
    v_mfma_f32_32x32x16_bf16 v[240:255], v[16:19], v[24:27], v[240:255]
    v_exp_f32 v52, v52
    v_exp_f32 v53, v53
    s_waitcnt lgkmcnt(0)
    v_mfma_f32_32x32x16_bf16 v[192:207], v[32:35], v[40:43], v[192:207]
    ds_read_b128 v[20:23], v4 offset:49952
    ds_read_b128 v[24:27], v4 offset:50080
    ds_read_b64_tr_b16 v[12:13], v62 offset:26112
    v_exp_f32 v54, v54
    v_mfma_f32_32x32x16_bf16 v[208:223], v[32:35], v[44:47], v[208:223]
    ds_read_b64_tr_b16 v[14:15], v62 offset:26240
    ds_read_b64_tr_b16 v[16:17], v62 offset:26144
    ds_read_b64_tr_b16 v[18:19], v62 offset:26272
    v_exp_f32 v55, v55
    v_mfma_f32_32x32x16_bf16 v[224:239], v[36:39], v[40:43], v[224:239]
    v_mul_f32 v144, v144, v152
    v_mul_f32 v145, v145, v153
    v_mul_f32 v146, v146, v154
    v_mul_f32 v147, v147, v155
    v_fma_f32 v52, v52, v90, v90
    v_mfma_f32_32x32x16_bf16 v[240:255], v[36:39], v[44:47], v[240:255]
    v_fma_f32 v53, v53, v90, v90
    v_fma_f32 v54, v54, v90, v90
    v_fma_f32 v55, v55, v90, v90
    v_rcp_f32 v52, v52
    s_waitcnt lgkmcnt(0)
    s_barrier
    v_mfma_f32_32x32x16_bf16 v[192:207], v[12:15], v[20:23], v[192:207]
    ds_read_b128 v[40:43], v4 offset:49984
    ds_read_b128 v[44:47], v4 offset:50112
    ds_read_b64_tr_b16 v[32:33], v62 offset:38400
    v_rcp_f32 v53, v53
    v_mfma_f32_32x32x16_bf16 v[208:223], v[12:15], v[24:27], v[208:223]
    ds_read_b64_tr_b16 v[34:35], v62 offset:38528
    ds_read_b64_tr_b16 v[36:37], v62 offset:38432
    ds_read_b64_tr_b16 v[38:39], v62 offset:38560
    v_rcp_f32 v54, v54
    v_mfma_f32_32x32x16_bf16 v[224:239], v[16:19], v[20:23], v[224:239]
    v_rcp_f32 v55, v55
    v_mul_f32 v144, v144, v52
    v_mul_f32 v145, v145, v53
    v_mul_f32 v146, v146, v54
    v_mfma_f32_32x32x16_bf16 v[240:255], v[16:19], v[24:27], v[240:255]
    v_mul_f32 v147, v147, v55
    v_cvt_pk_bf16_f32 v152, v144, v145
    v_cvt_pk_bf16_f32 v153, v146, v147
    v_mul_f32 v56, v148, v148
    v_mul_f32 v57, v149, v149
    s_waitcnt lgkmcnt(0)
    v_mfma_f32_32x32x16_bf16 v[192:207], v[32:35], v[40:43], v[192:207]
    ds_read_b128 v[20:23], v4 offset:50016
    ds_read_b128 v[24:27], v4 offset:50144
    ds_read_b64_tr_b16 v[12:13], v62 offset:38912
    v_mul_f32 v58, v150, v150
    v_mul_f32 v59, v151, v151
    v_mfma_f32_32x32x16_bf16 v[208:223], v[32:35], v[44:47], v[208:223]
    ds_read_b64_tr_b16 v[14:15], v62 offset:39040
    ds_read_b64_tr_b16 v[16:17], v62 offset:38944
    ds_read_b64_tr_b16 v[18:19], v62 offset:39072
    v_fma_f32 v56, v56, v88, v89
    v_fma_f32 v57, v57, v88, v89
    v_mfma_f32_32x32x16_bf16 v[224:239], v[36:39], v[40:43], v[224:239]
    v_fma_f32 v58, v58, v88, v89
    v_fma_f32 v59, v59, v88, v89
    v_mul_f32 v56, v56, v148
    v_mul_f32 v57, v57, v149
    v_mul_f32 v58, v58, v150
    v_mfma_f32_32x32x16_bf16 v[240:255], v[36:39], v[44:47], v[240:255]
    v_mul_f32 v59, v59, v151
    v_exp_f32 v56, v56
    v_exp_f32 v57, v57
    s_waitcnt lgkmcnt(0)
    s_barrier
    v_mfma_f32_32x32x16_bf16 v[192:207], v[12:15], v[20:23], v[192:207]
    ds_read_b128 v[40:43], v4 offset:33280
    ds_read_b128 v[44:47], v4 offset:33408
    ds_read_b64_tr_b16 v[32:33], v62 offset:0
    v_exp_f32 v58, v58
    v_mfma_f32_32x32x16_bf16 v[208:223], v[12:15], v[24:27], v[208:223]
    ds_read_b64_tr_b16 v[34:35], v62 offset:128
    ds_read_b64_tr_b16 v[36:37], v62 offset:32
    ds_read_b64_tr_b16 v[38:39], v62 offset:160
    v_exp_f32 v59, v59
    v_mfma_f32_32x32x16_bf16 v[224:239], v[16:19], v[20:23], v[224:239]
    v_mul_f32 v148, v148, v156
    v_mul_f32 v149, v149, v157
    v_mul_f32 v150, v150, v158
    v_mul_f32 v151, v151, v159
    v_fma_f32 v56, v56, v90, v90
    v_mfma_f32_32x32x16_bf16 v[240:255], v[16:19], v[24:27], v[240:255]
    v_fma_f32 v57, v57, v90, v90
    v_fma_f32 v58, v58, v90, v90
    v_fma_f32 v59, v59, v90, v90
    v_rcp_f32 v56, v56
    s_waitcnt lgkmcnt(0)
    v_mfma_f32_32x32x16_bf16 v[192:207], v[32:35], v[40:43], v[192:207]
    ds_read_b128 v[20:23], v4 offset:33312
    ds_read_b128 v[24:27], v4 offset:33440
    ds_read_b64_tr_b16 v[12:13], v62 offset:512
    v_rcp_f32 v57, v57
    v_mfma_f32_32x32x16_bf16 v[208:223], v[32:35], v[44:47], v[208:223]
    ds_read_b64_tr_b16 v[14:15], v62 offset:640
    ds_read_b64_tr_b16 v[16:17], v62 offset:544
    ds_read_b64_tr_b16 v[18:19], v62 offset:672
    v_rcp_f32 v58, v58
    v_mfma_f32_32x32x16_bf16 v[224:239], v[36:39], v[40:43], v[224:239]
    v_rcp_f32 v59, v59
    v_mul_f32 v148, v148, v56
    v_mul_f32 v149, v149, v57
    v_mul_f32 v150, v150, v58
    v_mfma_f32_32x32x16_bf16 v[240:255], v[36:39], v[44:47], v[240:255]
    v_mul_f32 v151, v151, v59
    v_cvt_pk_bf16_f32 v154, v148, v149
    v_cvt_pk_bf16_f32 v155, v150, v151
    v_mul_f32 v52, v176, v176
    v_mul_f32 v53, v177, v177
    s_waitcnt lgkmcnt(0)
    s_barrier
    v_mfma_f32_32x32x16_bf16 v[192:207], v[12:15], v[20:23], v[192:207]
    ds_read_b128 v[40:43], v4 offset:33344
    ds_read_b128 v[44:47], v4 offset:33472
    ds_read_b64_tr_b16 v[32:33], v62 offset:12800
    v_mul_f32 v54, v178, v178
    v_mul_f32 v55, v179, v179
    v_mfma_f32_32x32x16_bf16 v[208:223], v[12:15], v[24:27], v[208:223]
    ds_read_b64_tr_b16 v[34:35], v62 offset:12928
    ds_read_b64_tr_b16 v[36:37], v62 offset:12832
    ds_read_b64_tr_b16 v[38:39], v62 offset:12960
    v_fma_f32 v52, v52, v88, v89
    v_fma_f32 v53, v53, v88, v89
    v_mfma_f32_32x32x16_bf16 v[224:239], v[16:19], v[20:23], v[224:239]
    v_fma_f32 v54, v54, v88, v89
    v_fma_f32 v55, v55, v88, v89
    v_mul_f32 v52, v52, v176
    v_mul_f32 v53, v53, v177
    v_mul_f32 v54, v54, v178
    v_mfma_f32_32x32x16_bf16 v[240:255], v[16:19], v[24:27], v[240:255]
    v_mul_f32 v55, v55, v179
    v_exp_f32 v52, v52
    v_exp_f32 v53, v53
    s_waitcnt lgkmcnt(0)
    v_mfma_f32_32x32x16_bf16 v[192:207], v[32:35], v[40:43], v[192:207]
    ds_read_b128 v[20:23], v4 offset:33376
    ds_read_b128 v[24:27], v4 offset:33504
    ds_read_b64_tr_b16 v[12:13], v62 offset:13312
    v_exp_f32 v54, v54
    v_mfma_f32_32x32x16_bf16 v[208:223], v[32:35], v[44:47], v[208:223]
    ds_read_b64_tr_b16 v[14:15], v62 offset:13440
    ds_read_b64_tr_b16 v[16:17], v62 offset:13344
    ds_read_b64_tr_b16 v[18:19], v62 offset:13472
    v_exp_f32 v55, v55
    v_mfma_f32_32x32x16_bf16 v[224:239], v[36:39], v[40:43], v[224:239]
    v_mul_f32 v176, v176, v184
    v_mul_f32 v177, v177, v185
    v_mul_f32 v178, v178, v186
    v_mul_f32 v179, v179, v187
    v_fma_f32 v52, v52, v90, v90
    v_mfma_f32_32x32x16_bf16 v[240:255], v[36:39], v[44:47], v[240:255]
    v_fma_f32 v53, v53, v90, v90
    v_fma_f32 v54, v54, v90, v90
    v_fma_f32 v55, v55, v90, v90
    v_rcp_f32 v52, v52
    s_waitcnt lgkmcnt(0)
    s_barrier
    v_mfma_f32_32x32x16_bf16 v[192:207], v[12:15], v[20:23], v[192:207]
    ds_read_b128 v[40:43], v4 offset:16640
    ds_read_b128 v[44:47], v4 offset:16768
    ds_read_b64_tr_b16 v[32:33], v62 offset:51200
    v_rcp_f32 v53, v53
    v_mfma_f32_32x32x16_bf16 v[208:223], v[12:15], v[24:27], v[208:223]
    ds_read_b64_tr_b16 v[34:35], v62 offset:51328
    ds_read_b64_tr_b16 v[36:37], v62 offset:51232
    ds_read_b64_tr_b16 v[38:39], v62 offset:51360
    v_rcp_f32 v54, v54
    v_mfma_f32_32x32x16_bf16 v[224:239], v[16:19], v[20:23], v[224:239]
    v_rcp_f32 v55, v55
    v_mul_f32 v176, v176, v52
    v_mul_f32 v177, v177, v53
    v_mul_f32 v178, v178, v54
    v_mfma_f32_32x32x16_bf16 v[240:255], v[16:19], v[24:27], v[240:255]
    v_mul_f32 v179, v179, v55
    v_cvt_pk_bf16_f32 v184, v176, v177
    v_cvt_pk_bf16_f32 v185, v178, v179
    v_mul_f32 v56, v180, v180
    v_mul_f32 v57, v181, v181
    s_waitcnt lgkmcnt(0)
    v_mfma_f32_32x32x16_bf16 v[192:207], v[32:35], v[40:43], v[192:207]
    ds_read_b128 v[20:23], v4 offset:16672
    ds_read_b128 v[24:27], v4 offset:16800
    ds_read_b64_tr_b16 v[12:13], v62 offset:51712
    v_mul_f32 v58, v182, v182
    v_mul_f32 v59, v183, v183
    v_mfma_f32_32x32x16_bf16 v[208:223], v[32:35], v[44:47], v[208:223]
    ds_read_b64_tr_b16 v[14:15], v62 offset:51840
    ds_read_b64_tr_b16 v[16:17], v62 offset:51744
    ds_read_b64_tr_b16 v[18:19], v62 offset:51872
    v_fma_f32 v56, v56, v88, v89
    v_fma_f32 v57, v57, v88, v89
    v_mfma_f32_32x32x16_bf16 v[224:239], v[36:39], v[40:43], v[224:239]
    v_fma_f32 v58, v58, v88, v89
    v_fma_f32 v59, v59, v88, v89
    v_mul_f32 v56, v56, v180
    v_mul_f32 v57, v57, v181
    v_mul_f32 v58, v58, v182
    v_mfma_f32_32x32x16_bf16 v[240:255], v[36:39], v[44:47], v[240:255]
    v_mul_f32 v59, v59, v183
    v_exp_f32 v56, v56
    v_exp_f32 v57, v57
    s_waitcnt lgkmcnt(0)
    s_barrier
    v_mfma_f32_32x32x16_bf16 v[192:207], v[12:15], v[20:23], v[192:207]
    ds_read_b128 v[40:43], v4 offset:16704
    ds_read_b128 v[44:47], v4 offset:16832
    ds_read_b64_tr_b16 v[32:33], v62 offset:64000
    v_exp_f32 v58, v58
    v_mfma_f32_32x32x16_bf16 v[208:223], v[12:15], v[24:27], v[208:223]
    ds_read_b64_tr_b16 v[34:35], v62 offset:64128
    ds_read_b64_tr_b16 v[36:37], v62 offset:64032
    ds_read_b64_tr_b16 v[38:39], v62 offset:64160
    v_exp_f32 v59, v59
    v_mfma_f32_32x32x16_bf16 v[224:239], v[16:19], v[20:23], v[224:239]
    v_mul_f32 v180, v180, v188
    v_mul_f32 v181, v181, v189
    v_mul_f32 v182, v182, v190
    v_mul_f32 v183, v183, v191
    v_fma_f32 v56, v56, v90, v90
    v_mfma_f32_32x32x16_bf16 v[240:255], v[16:19], v[24:27], v[240:255]
    v_fma_f32 v57, v57, v90, v90
    v_fma_f32 v58, v58, v90, v90
    v_fma_f32 v59, v59, v90, v90
    v_rcp_f32 v56, v56
    s_waitcnt lgkmcnt(0)
    v_mfma_f32_32x32x16_bf16 v[192:207], v[32:35], v[40:43], v[192:207]
    ds_read_b128 v[20:23], v4 offset:16736
    ds_read_b128 v[24:27], v4 offset:16864
    ds_read_b64_tr_b16 v[12:13], v62 offset:64512
    v_rcp_f32 v57, v57
    v_mfma_f32_32x32x16_bf16 v[208:223], v[32:35], v[44:47], v[208:223]
    ds_read_b64_tr_b16 v[14:15], v62 offset:64640
    ds_read_b64_tr_b16 v[16:17], v62 offset:64544
    ds_read_b64_tr_b16 v[18:19], v62 offset:64672
    v_rcp_f32 v58, v58
    v_mfma_f32_32x32x16_bf16 v[224:239], v[36:39], v[40:43], v[224:239]
    v_rcp_f32 v59, v59
    v_mul_f32 v180, v180, v56
    v_mul_f32 v181, v181, v57
    v_mul_f32 v182, v182, v58
    v_mfma_f32_32x32x16_bf16 v[240:255], v[36:39], v[44:47], v[240:255]
    v_mul_f32 v183, v183, v59
    v_cvt_pk_bf16_f32 v186, v180, v181
    v_cvt_pk_bf16_f32 v187, v182, v183
    s_waitcnt lgkmcnt(0)
    s_barrier
    v_mfma_f32_32x32x16_bf16 v[192:207], v[12:15], v[20:23], v[192:207]
    v_mfma_f32_32x32x16_bf16 v[208:223], v[12:15], v[24:27], v[208:223]
    v_mfma_f32_32x32x16_bf16 v[224:239], v[16:19], v[20:23], v[224:239]
    v_mfma_f32_32x32x16_bf16 v[240:255], v[16:19], v[24:27], v[240:255]
    ds_write_b128 v77, v[136:139] offset:0
    ds_write_b128 v77, v[168:171] offset:4096
    ds_write_b128 v77, v[152:155] offset:8192
    ds_write_b128 v77, v[184:187] offset:12288
LC_g4:
    v_mov_b32 v1, v63
    s_nop 6
    v_pk_mul_f32 v[8:9], v[192:193], v[192:193]
    v_pk_mul_f32 v[10:11], v[194:195], v[194:195]
    v_pk_mul_f32 v[12:13], v[196:197], v[196:197]
    v_pk_mul_f32 v[14:15], v[198:199], v[198:199]
    v_pk_mul_f32 v[16:17], v[208:209], v[208:209]
    v_pk_mul_f32 v[18:19], v[210:211], v[210:211]
    v_pk_mul_f32 v[20:21], v[212:213], v[212:213]
    v_pk_mul_f32 v[22:23], v[214:215], v[214:215]
    v_pk_fma_f32 v[8:9], v[8:9], v[80:81], v[80:81] op_sel:[0,0,1] op_sel_hi:[1,0,1]
    v_pk_fma_f32 v[10:11], v[10:11], v[80:81], v[80:81] op_sel:[0,0,1] op_sel_hi:[1,0,1]
    v_pk_fma_f32 v[12:13], v[12:13], v[80:81], v[80:81] op_sel:[0,0,1] op_sel_hi:[1,0,1]
    v_pk_fma_f32 v[14:15], v[14:15], v[80:81], v[80:81] op_sel:[0,0,1] op_sel_hi:[1,0,1]
    v_pk_fma_f32 v[16:17], v[16:17], v[88:89], v[88:89] op_sel:[0,0,1] op_sel_hi:[1,0,1]
    v_pk_fma_f32 v[18:19], v[18:19], v[88:89], v[88:89] op_sel:[0,0,1] op_sel_hi:[1,0,1]
    v_pk_fma_f32 v[20:21], v[20:21], v[88:89], v[88:89] op_sel:[0,0,1] op_sel_hi:[1,0,1]
    v_pk_fma_f32 v[22:23], v[22:23], v[88:89], v[88:89] op_sel:[0,0,1] op_sel_hi:[1,0,1]
    v_pk_mul_f32 v[8:9], v[8:9], v[192:193]
    v_pk_mul_f32 v[10:11], v[10:11], v[194:195]
    v_pk_mul_f32 v[12:13], v[12:13], v[196:197]
    v_pk_mul_f32 v[14:15], v[14:15], v[198:199]
    v_pk_mul_f32 v[16:17], v[16:17], v[208:209]
    v_pk_mul_f32 v[18:19], v[18:19], v[210:211]
    v_pk_mul_f32 v[20:21], v[20:21], v[212:213]
    v_pk_mul_f32 v[22:23], v[22:23], v[214:215]
    v_exp_f32 v8, v8
    v_exp_f32 v9, v9
    v_exp_f32 v10, v10
    v_exp_f32 v11, v11
    v_exp_f32 v12, v12
    v_exp_f32 v13, v13
    v_exp_f32 v14, v14
    v_exp_f32 v15, v15
    v_exp_f32 v16, v16
    v_exp_f32 v17, v17
    v_exp_f32 v18, v18
    v_exp_f32 v19, v19
    v_exp_f32 v20, v20
    v_exp_f32 v21, v21
    v_exp_f32 v22, v22
    v_exp_f32 v23, v23
    v_pk_mul_f32 v[192:193], v[192:193], v[200:201]
    v_pk_mul_f32 v[194:195], v[194:195], v[202:203]
    v_pk_mul_f32 v[196:197], v[196:197], v[204:205]
    v_pk_mul_f32 v[198:199], v[198:199], v[206:207]
    v_pk_mul_f32 v[208:209], v[208:209], v[216:217]
    v_pk_mul_f32 v[210:211], v[210:211], v[218:219]
    v_pk_mul_f32 v[212:213], v[212:213], v[220:221]
    v_pk_mul_f32 v[214:215], v[214:215], v[222:223]
    v_pk_fma_f32 v[8:9], v[8:9], v[82:83], v[82:83] op_sel:[0,0,0] op_sel_hi:[1,0,0]
    v_pk_fma_f32 v[10:11], v[10:11], v[82:83], v[82:83] op_sel:[0,0,0] op_sel_hi:[1,0,0]
    v_pk_fma_f32 v[12:13], v[12:13], v[82:83], v[82:83] op_sel:[0,0,0] op_sel_hi:[1,0,0]
    v_pk_fma_f32 v[14:15], v[14:15], v[82:83], v[82:83] op_sel:[0,0,0] op_sel_hi:[1,0,0]
    v_pk_fma_f32 v[16:17], v[16:17], v[90:91], v[90:91] op_sel:[0,0,0] op_sel_hi:[1,0,0]
    v_pk_fma_f32 v[18:19], v[18:19], v[90:91], v[90:91] op_sel:[0,0,0] op_sel_hi:[1,0,0]
    v_pk_fma_f32 v[20:21], v[20:21], v[90:91], v[90:91] op_sel:[0,0,0] op_sel_hi:[1,0,0]
    v_pk_fma_f32 v[22:23], v[22:23], v[90:91], v[90:91] op_sel:[0,0,0] op_sel_hi:[1,0,0]
    v_rcp_f32 v8, v8
    v_rcp_f32 v9, v9
    v_rcp_f32 v10, v10
    v_rcp_f32 v11, v11
    v_rcp_f32 v12, v12
    v_rcp_f32 v13, v13
    v_rcp_f32 v14, v14
    v_rcp_f32 v15, v15
    v_rcp_f32 v16, v16
    v_rcp_f32 v17, v17
    v_rcp_f32 v18, v18
    v_rcp_f32 v19, v19
    v_rcp_f32 v20, v20
    v_rcp_f32 v21, v21
    v_rcp_f32 v22, v22
    v_rcp_f32 v23, v23
    v_pk_mul_f32 v[192:193], v[192:193], v[8:9]
    v_pk_mul_f32 v[194:195], v[194:195], v[10:11]
    v_pk_mul_f32 v[196:197], v[196:197], v[12:13]
    v_pk_mul_f32 v[198:199], v[198:199], v[14:15]
    v_pk_mul_f32 v[208:209], v[208:209], v[16:17]
    v_pk_mul_f32 v[210:211], v[210:211], v[18:19]
    v_pk_mul_f32 v[212:213], v[212:213], v[20:21]
    v_pk_mul_f32 v[214:215], v[214:215], v[22:23]
    v_cvt_pk_bf16_f32 v200, v192, v193
    v_cvt_pk_bf16_f32 v201, v194, v195
    v_cvt_pk_bf16_f32 v202, v196, v197
    v_cvt_pk_bf16_f32 v203, v198, v199
    ds_write_b128 v77, v[200:203] offset:16384
    v_cvt_pk_bf16_f32 v216, v208, v209
    v_cvt_pk_bf16_f32 v217, v210, v211
    v_cvt_pk_bf16_f32 v218, v212, v213
    v_cvt_pk_bf16_f32 v219, v214, v215
    ds_write_b128 v77, v[216:219] offset:24576
    v_pk_mul_f32 v[8:9], v[224:225], v[224:225]
    v_pk_mul_f32 v[10:11], v[226:227], v[226:227]
    v_pk_mul_f32 v[12:13], v[228:229], v[228:229]
    v_pk_mul_f32 v[14:15], v[230:231], v[230:231]
    v_pk_mul_f32 v[16:17], v[240:241], v[240:241]
    v_pk_mul_f32 v[18:19], v[242:243], v[242:243]
    v_pk_mul_f32 v[20:21], v[244:245], v[244:245]
    v_pk_mul_f32 v[22:23], v[246:247], v[246:247]
    v_pk_fma_f32 v[8:9], v[8:9], v[80:81], v[80:81] op_sel:[0,0,1] op_sel_hi:[1,0,1]
    v_pk_fma_f32 v[10:11], v[10:11], v[80:81], v[80:81] op_sel:[0,0,1] op_sel_hi:[1,0,1]
    v_pk_fma_f32 v[12:13], v[12:13], v[80:81], v[80:81] op_sel:[0,0,1] op_sel_hi:[1,0,1]
    v_pk_fma_f32 v[14:15], v[14:15], v[80:81], v[80:81] op_sel:[0,0,1] op_sel_hi:[1,0,1]
    v_pk_fma_f32 v[16:17], v[16:17], v[88:89], v[88:89] op_sel:[0,0,1] op_sel_hi:[1,0,1]
    v_pk_fma_f32 v[18:19], v[18:19], v[88:89], v[88:89] op_sel:[0,0,1] op_sel_hi:[1,0,1]
    v_pk_fma_f32 v[20:21], v[20:21], v[88:89], v[88:89] op_sel:[0,0,1] op_sel_hi:[1,0,1]
    v_pk_fma_f32 v[22:23], v[22:23], v[88:89], v[88:89] op_sel:[0,0,1] op_sel_hi:[1,0,1]
    v_pk_mul_f32 v[8:9], v[8:9], v[224:225]
    v_pk_mul_f32 v[10:11], v[10:11], v[226:227]
    v_pk_mul_f32 v[12:13], v[12:13], v[228:229]
    v_pk_mul_f32 v[14:15], v[14:15], v[230:231]
    v_pk_mul_f32 v[16:17], v[16:17], v[240:241]
    v_pk_mul_f32 v[18:19], v[18:19], v[242:243]
    v_pk_mul_f32 v[20:21], v[20:21], v[244:245]
    v_pk_mul_f32 v[22:23], v[22:23], v[246:247]
    v_exp_f32 v8, v8
    v_exp_f32 v9, v9
    v_exp_f32 v10, v10
    v_exp_f32 v11, v11
    v_exp_f32 v12, v12
    v_exp_f32 v13, v13
    v_exp_f32 v14, v14
    v_exp_f32 v15, v15
    v_exp_f32 v16, v16
    v_exp_f32 v17, v17
    v_exp_f32 v18, v18
    v_exp_f32 v19, v19
    v_exp_f32 v20, v20
    v_exp_f32 v21, v21
    v_exp_f32 v22, v22
    v_exp_f32 v23, v23
    v_pk_mul_f32 v[224:225], v[224:225], v[232:233]
    v_pk_mul_f32 v[226:227], v[226:227], v[234:235]
    v_pk_mul_f32 v[228:229], v[228:229], v[236:237]
    v_pk_mul_f32 v[230:231], v[230:231], v[238:239]
    v_pk_mul_f32 v[240:241], v[240:241], v[248:249]
    v_pk_mul_f32 v[242:243], v[242:243], v[250:251]
    v_pk_mul_f32 v[244:245], v[244:245], v[252:253]
    v_pk_mul_f32 v[246:247], v[246:247], v[254:255]
    v_pk_fma_f32 v[8:9], v[8:9], v[82:83], v[82:83] op_sel:[0,0,0] op_sel_hi:[1,0,0]
    v_pk_fma_f32 v[10:11], v[10:11], v[82:83], v[82:83] op_sel:[0,0,0] op_sel_hi:[1,0,0]
    v_pk_fma_f32 v[12:13], v[12:13], v[82:83], v[82:83] op_sel:[0,0,0] op_sel_hi:[1,0,0]
    v_pk_fma_f32 v[14:15], v[14:15], v[82:83], v[82:83] op_sel:[0,0,0] op_sel_hi:[1,0,0]
    v_pk_fma_f32 v[16:17], v[16:17], v[90:91], v[90:91] op_sel:[0,0,0] op_sel_hi:[1,0,0]
    v_pk_fma_f32 v[18:19], v[18:19], v[90:91], v[90:91] op_sel:[0,0,0] op_sel_hi:[1,0,0]
    v_pk_fma_f32 v[20:21], v[20:21], v[90:91], v[90:91] op_sel:[0,0,0] op_sel_hi:[1,0,0]
    v_pk_fma_f32 v[22:23], v[22:23], v[90:91], v[90:91] op_sel:[0,0,0] op_sel_hi:[1,0,0]
    v_rcp_f32 v8, v8
    v_rcp_f32 v9, v9
    v_rcp_f32 v10, v10
    v_rcp_f32 v11, v11
    v_rcp_f32 v12, v12
    v_rcp_f32 v13, v13
    v_rcp_f32 v14, v14
    v_rcp_f32 v15, v15
    v_rcp_f32 v16, v16
    v_rcp_f32 v17, v17
    v_rcp_f32 v18, v18
    v_rcp_f32 v19, v19
    v_rcp_f32 v20, v20
    v_rcp_f32 v21, v21
    v_rcp_f32 v22, v22
    v_rcp_f32 v23, v23
    v_pk_mul_f32 v[224:225], v[224:225], v[8:9]
    v_pk_mul_f32 v[226:227], v[226:227], v[10:11]
    v_pk_mul_f32 v[228:229], v[228:229], v[12:13]
    v_pk_mul_f32 v[230:231], v[230:231], v[14:15]
    v_pk_mul_f32 v[240:241], v[240:241], v[16:17]
    v_pk_mul_f32 v[242:243], v[242:243], v[18:19]
    v_pk_mul_f32 v[244:245], v[244:245], v[20:21]
    v_pk_mul_f32 v[246:247], v[246:247], v[22:23]
    v_cvt_pk_bf16_f32 v232, v224, v225
    v_cvt_pk_bf16_f32 v233, v226, v227
    v_cvt_pk_bf16_f32 v234, v228, v229
    v_cvt_pk_bf16_f32 v235, v230, v231
    ds_write_b128 v77, v[232:235] offset:20480
    v_cvt_pk_bf16_f32 v248, v240, v241
    v_cvt_pk_bf16_f32 v249, v242, v243
    v_cvt_pk_bf16_f32 v250, v244, v245
    v_cvt_pk_bf16_f32 v251, v246, v247
    ds_write_b128 v77, v[248:251] offset:28672
LC_att:
    s_waitcnt lgkmcnt(0)
    s_barrier
    ds_read_b128 v[8:11], v74 offset:512
    ds_read_b128 v[128:131], v1
    ds_read_b128 v[132:135], v1 offset:2048
    ds_read_b128 v[12:15], v74 offset:2560
    v_mov_b32 v2, v1
    v_mov_b32 v3, v72
    v_mov_b32 v4, v73
    s_mov_b32 s50, 0
    v_mov_b32 v5, 163344
    v_mov_b64 v[136:137], 0
    v_mov_b64 v[138:139], 0
    v_mov_b64 v[140:141], 0
    v_mov_b64 v[142:143], 0
    v_mov_b64 v[120:121], 0
    v_mov_b64 v[122:123], 0
    v_mov_b64 v[124:125], 0
    v_mov_b64 v[126:127], 0
    s_waitcnt lgkmcnt(2)
    v_mfma_f32_32x32x16_bf16 v[80:95], v[128:131], v[8:11], 0
    s_waitcnt lgkmcnt(1)
    v_mfma_f32_32x32x16_bf16 v[48:63], v[132:135], v[8:11], 0
    s_waitcnt lgkmcnt(0)
    v_mfma_f32_32x32x16_bf16 v[96:111], v[128:131], v[12:15], 0
    v_mfma_f32_32x32x16_bf16 v[64:79], v[132:135], v[12:15], 0
    s_nop 6
    v_max3_f32 v16, v80, v81, v82
    v_max3_f32 v17, v83, v84, v85
    v_max3_f32 v16, v16, v86, v87
    v_max3_f32 v17, v17, v88, v89
    v_max3_f32 v16, v16, v90, v91
    v_max3_f32 v17, v17, v92, v93
    v_max3_f32 v16, v16, v94, v95
    v_max3_f32 v17, v17, v48, v49
    v_max3_f32 v16, v16, v50, v51
    v_max3_f32 v17, v17, v52, v53
    v_max3_f32 v16, v16, v54, v55
    v_max3_f32 v17, v17, v56, v57
    v_max3_f32 v16, v16, v58, v59
    v_max3_f32 v17, v17, v60, v61
    v_max3_f32 v16, v16, v62, v63
    v_mov_b64 v[48:49], 0
    v_max_f32 v16, v16, v17
    v_mov_b32 v17, v16
    v_mov_b64 v[50:51], 0
    v_mov_b64 v[52:53], 0
    v_permlane32_swap_b32 v16, v17
    v_max_f32 v16, v16, v17
    v_sub_f32 v17, 0xc2d00000, v16
    v_sub_f32 v16, 0xc2d00000, v16
    v_mov_b64 v[18:19], v[16:17]
    v_mov_b64 v[20:21], v[16:17]
    v_mov_b64 v[22:23], v[16:17]
    v_mov_b64 v[24:25], v[16:17]
    v_mov_b64 v[26:27], v[16:17]
    v_mov_b64 v[28:29], v[16:17]
    v_mov_b64 v[30:31], v[16:17]
    v_mov_b64 v[54:55], 0
    v_mov_b64 v[56:57], 0
    v_mfma_f32_32x32x16_bf16 v[80:95], v[128:131], v[8:11], v[16:31]
    v_max3_f32 v32, v96, v97, v98
    v_max3_f32 v33, v99, v100, v101
    v_max3_f32 v32, v32, v102, v103
    v_max3_f32 v33, v33, v104, v105
    v_max3_f32 v32, v32, v106, v107
    v_max3_f32 v33, v33, v108, v109
    v_max3_f32 v32, v32, v110, v111
    v_max3_f32 v33, v33, v64, v65
    v_max3_f32 v32, v32, v66, v67
    v_max3_f32 v33, v33, v68, v69
    v_max3_f32 v32, v32, v70, v71
    v_max3_f32 v33, v33, v72, v73
    v_max3_f32 v32, v32, v74, v75
    v_max3_f32 v33, v33, v76, v77
    v_max3_f32 v32, v32, v78, v79
    v_mov_b64 v[64:65], 0
    v_max_f32 v32, v32, v33
    v_mov_b32 v33, v32
    v_mov_b64 v[66:67], 0
    v_mov_b64 v[68:69], 0
    v_permlane32_swap_b32 v32, v33
    v_max_f32 v32, v32, v33
    v_sub_f32 v33, 0xc2d00000, v32
    v_sub_f32 v32, 0xc2d00000, v32
    v_mov_b64 v[34:35], v[32:33]
    v_mov_b64 v[36:37], v[32:33]
    v_mov_b64 v[38:39], v[32:33]
    v_mov_b64 v[40:41], v[32:33]
    v_mov_b64 v[42:43], v[32:33]
    v_mov_b64 v[44:45], v[32:33]
    v_mov_b64 v[46:47], v[32:33]
    v_mov_b64 v[70:71], 0
    v_mov_b64 v[72:73], 0
    s_nop 0
.p2align 3
LA_loop:
    v_mfma_f32_32x32x16_bf16 v[96:111], v[128:131], v[12:15], v[32:47]
    ds_read_b128 v[128:131], v2 offset:4096
    v_exp_f32 v80, v80
    v_exp_f32 v81, v81
    v_exp_f32 v82, v82
    v_mfma_f32_32x32x16_bf16 v[64:79], v[136:139], v[120:123], v[64:79]
    ds_read_b128 v[136:139], v3 offset:1024
    v_exp_f32 v83, v83
    v_exp_f32 v84, v84
    v_exp_f32 v85, v85
    v_mfma_f32_32x32x16_bf16 v[64:79], v[140:143], v[124:127], v[64:79]
    ds_read_b128 v[140:143], v3 offset:1280
    v_cvt_pk_bf16_f32 v112, v80, v81
    v_cvt_pk_bf16_f32 v113, v82, v83
    v_cvt_pk_bf16_f32 v114, v84, v85
    v_exp_f32 v86, v86
    v_exp_f32 v87, v87
    v_exp_f32 v88, v88
    v_cvt_pk_bf16_f32 v115, v86, v87
    v_exp_f32 v89, v89
    v_exp_f32 v90, v90
    v_cvt_pk_bf16_f32 v116, v88, v89
    v_exp_f32 v91, v91
    v_exp_f32 v92, v92
    v_cvt_pk_bf16_f32 v117, v90, v91
    v_exp_f32 v93, v93
    v_exp_f32 v94, v94
    v_exp_f32 v95, v95
    v_cvt_pk_bf16_f32 v118, v92, v93
    v_cvt_pk_bf16_f32 v119, v94, v95
    v_mfma_f32_32x32x16_bf16 v[80:95], v[132:135], v[8:11], v[16:31]
    s_waitcnt lgkmcnt(1)
    v_exp_f32 v96, v96
    v_exp_f32 v97, v97
    v_exp_f32 v98, v98
    v_mfma_f32_32x32x16_bf16 v[48:63], v[136:139], v[112:115], v[48:63]
    s_waitcnt lgkmcnt(0)
    v_exp_f32 v99, v99
    v_exp_f32 v100, v100
    v_exp_f32 v101, v101
    v_mfma_f32_32x32x16_bf16 v[48:63], v[140:143], v[116:119], v[48:63]
    v_cvt_pk_bf16_f32 v120, v96, v97
    v_cvt_pk_bf16_f32 v121, v98, v99
    v_cvt_pk_bf16_f32 v122, v100, v101
    v_exp_f32 v102, v102
    v_exp_f32 v103, v103
    v_exp_f32 v104, v104
    v_cvt_pk_bf16_f32 v123, v102, v103
    v_exp_f32 v105, v105
    v_exp_f32 v106, v106
    v_cvt_pk_bf16_f32 v124, v104, v105
    v_exp_f32 v107, v107
    v_exp_f32 v108, v108
    v_cvt_pk_bf16_f32 v125, v106, v107
    v_exp_f32 v109, v109
    v_exp_f32 v110, v110
    v_exp_f32 v111, v111
    v_cvt_pk_bf16_f32 v126, v108, v109
    v_cvt_pk_bf16_f32 v127, v110, v111
    v_mfma_f32_32x32x16_bf16 v[96:111], v[132:135], v[12:15], v[32:47]
    ds_read_b128 v[132:135], v2 offset:6144
    v_exp_f32 v80, v80
    v_exp_f32 v81, v81
    v_exp_f32 v82, v82
    v_mfma_f32_32x32x16_bf16 v[64:79], v[136:139], v[120:123], v[64:79]
    ds_read_b128 v[136:139], v3 offset:3072
    v_exp_f32 v83, v83
    v_exp_f32 v84, v84
    v_exp_f32 v85, v85
    v_mfma_f32_32x32x16_bf16 v[64:79], v[140:143], v[124:127], v[64:79]
    ds_read_b128 v[140:143], v3 offset:3328
    v_cvt_pk_bf16_f32 v112, v80, v81
    v_cvt_pk_bf16_f32 v113, v82, v83
    v_cvt_pk_bf16_f32 v114, v84, v85
    v_exp_f32 v86, v86
    v_exp_f32 v87, v87
    v_exp_f32 v88, v88
    v_cvt_pk_bf16_f32 v115, v86, v87
    v_exp_f32 v89, v89
    v_exp_f32 v90, v90
    v_cvt_pk_bf16_f32 v116, v88, v89
    v_exp_f32 v91, v91
    v_exp_f32 v92, v92
    v_cvt_pk_bf16_f32 v117, v90, v91
    v_exp_f32 v93, v93
    v_exp_f32 v94, v94
    v_exp_f32 v95, v95
    v_cvt_pk_bf16_f32 v118, v92, v93
    v_cvt_pk_bf16_f32 v119, v94, v95
    v_mfma_f32_32x32x16_bf16 v[80:95], v[128:131], v[8:11], v[16:31]
    s_waitcnt lgkmcnt(1)
    v_exp_f32 v96, v96
    v_exp_f32 v97, v97
    v_exp_f32 v98, v98
    v_mfma_f32_32x32x16_bf16 v[48:63], v[136:139], v[112:115], v[48:63]
    s_waitcnt lgkmcnt(0)
    v_exp_f32 v99, v99
    v_exp_f32 v100, v100
    v_exp_f32 v101, v101
    v_mfma_f32_32x32x16_bf16 v[48:63], v[140:143], v[116:119], v[48:63]
    v_cvt_pk_bf16_f32 v120, v96, v97
    v_cvt_pk_bf16_f32 v121, v98, v99
    v_cvt_pk_bf16_f32 v122, v100, v101
    v_exp_f32 v102, v102
    v_exp_f32 v103, v103
    v_exp_f32 v104, v104
    v_cvt_pk_bf16_f32 v123, v102, v103
    v_exp_f32 v105, v105
    v_exp_f32 v106, v106
    v_cvt_pk_bf16_f32 v124, v104, v105
    v_exp_f32 v107, v107
    v_exp_f32 v108, v108
    v_cvt_pk_bf16_f32 v125, v106, v107
    v_exp_f32 v109, v109
    v_exp_f32 v110, v110
    v_exp_f32 v111, v111
    v_cvt_pk_bf16_f32 v126, v108, v109
    v_cvt_pk_bf16_f32 v127, v110, v111
    v_mfma_f32_32x32x16_bf16 v[96:111], v[128:131], v[12:15], v[32:47]
    ds_read_b128 v[128:131], v2 offset:8192
    v_exp_f32 v80, v80
    v_exp_f32 v81, v81
    v_exp_f32 v82, v82
    v_mfma_f32_32x32x16_bf16 v[64:79], v[136:139], v[120:123], v[64:79]
    ds_read_b128 v[136:139], v3 offset:5120
    v_exp_f32 v83, v83
    v_exp_f32 v84, v84
    v_exp_f32 v85, v85
    v_mfma_f32_32x32x16_bf16 v[64:79], v[140:143], v[124:127], v[64:79]
    ds_read_b128 v[140:143], v3 offset:5376
    v_cvt_pk_bf16_f32 v112, v80, v81
    v_cvt_pk_bf16_f32 v113, v82, v83
    v_cvt_pk_bf16_f32 v114, v84, v85
    v_exp_f32 v86, v86
    v_exp_f32 v87, v87
    v_exp_f32 v88, v88
    v_cvt_pk_bf16_f32 v115, v86, v87
    v_exp_f32 v89, v89
    v_exp_f32 v90, v90
    v_cvt_pk_bf16_f32 v116, v88, v89
    v_exp_f32 v91, v91
    v_exp_f32 v92, v92
    v_cvt_pk_bf16_f32 v117, v90, v91
    v_exp_f32 v93, v93
    v_exp_f32 v94, v94
    v_exp_f32 v95, v95
    v_cvt_pk_bf16_f32 v118, v92, v93
    v_cvt_pk_bf16_f32 v119, v94, v95
    v_mfma_f32_32x32x16_bf16 v[80:95], v[132:135], v[8:11], v[16:31]
    s_waitcnt lgkmcnt(1)
    v_exp_f32 v96, v96
    v_exp_f32 v97, v97
    v_exp_f32 v98, v98
    v_mfma_f32_32x32x16_bf16 v[48:63], v[136:139], v[112:115], v[48:63]
    s_waitcnt lgkmcnt(0)
    v_exp_f32 v99, v99
    v_exp_f32 v100, v100
    v_exp_f32 v101, v101
    v_mfma_f32_32x32x16_bf16 v[48:63], v[140:143], v[116:119], v[48:63]
    v_cvt_pk_bf16_f32 v120, v96, v97
    v_cvt_pk_bf16_f32 v121, v98, v99
    v_cvt_pk_bf16_f32 v122, v100, v101
    v_exp_f32 v102, v102
    v_exp_f32 v103, v103
    v_exp_f32 v104, v104
    v_cvt_pk_bf16_f32 v123, v102, v103
    v_exp_f32 v105, v105
    v_exp_f32 v106, v106
    v_cvt_pk_bf16_f32 v124, v104, v105
    v_exp_f32 v107, v107
    v_exp_f32 v108, v108
    v_cvt_pk_bf16_f32 v125, v106, v107
    v_exp_f32 v109, v109
    v_exp_f32 v110, v110
    v_exp_f32 v111, v111
    v_cvt_pk_bf16_f32 v126, v108, v109
    v_cvt_pk_bf16_f32 v127, v110, v111
    v_mfma_f32_32x32x16_bf16 v[96:111], v[132:135], v[12:15], v[32:47]
    ds_read_b128 v[132:135], v2 offset:10240
    v_exp_f32 v80, v80
    v_exp_f32 v81, v81
    v_exp_f32 v82, v82
    v_mfma_f32_32x32x16_bf16 v[64:79], v[136:139], v[120:123], v[64:79]
    ds_read_b128 v[136:139], v3 offset:7168
    v_exp_f32 v83, v83
    v_exp_f32 v84, v84
    v_exp_f32 v85, v85
    v_mfma_f32_32x32x16_bf16 v[64:79], v[140:143], v[124:127], v[64:79]
    ds_read_b128 v[140:143], v3 offset:7424
    v_cvt_pk_bf16_f32 v112, v80, v81
    v_cvt_pk_bf16_f32 v113, v82, v83
    v_cvt_pk_bf16_f32 v114, v84, v85
    v_exp_f32 v86, v86
    v_exp_f32 v87, v87
    v_exp_f32 v88, v88
    v_cvt_pk_bf16_f32 v115, v86, v87
    v_exp_f32 v89, v89
    v_exp_f32 v90, v90
    v_cvt_pk_bf16_f32 v116, v88, v89
    v_exp_f32 v91, v91
    v_exp_f32 v92, v92
    v_cvt_pk_bf16_f32 v117, v90, v91
    v_exp_f32 v93, v93
    v_exp_f32 v94, v94
    v_exp_f32 v95, v95
    v_cvt_pk_bf16_f32 v118, v92, v93
    v_cvt_pk_bf16_f32 v119, v94, v95
    v_mfma_f32_32x32x16_bf16 v[80:95], v[128:131], v[8:11], v[16:31]
    s_waitcnt lgkmcnt(1)
    v_exp_f32 v96, v96
    v_exp_f32 v97, v97
    v_exp_f32 v98, v98
    v_mfma_f32_32x32x16_bf16 v[48:63], v[136:139], v[112:115], v[48:63]
    s_waitcnt lgkmcnt(0)
    v_exp_f32 v99, v99
    v_exp_f32 v100, v100
    v_exp_f32 v101, v101
    v_mfma_f32_32x32x16_bf16 v[48:63], v[140:143], v[116:119], v[48:63]
    v_cvt_pk_bf16_f32 v120, v96, v97
    v_cvt_pk_bf16_f32 v121, v98, v99
    v_cvt_pk_bf16_f32 v122, v100, v101
    v_exp_f32 v102, v102
    v_exp_f32 v103, v103
    v_exp_f32 v104, v104
    v_cvt_pk_bf16_f32 v123, v102, v103
    v_exp_f32 v105, v105
    v_exp_f32 v106, v106
    v_cvt_pk_bf16_f32 v124, v104, v105
    v_exp_f32 v107, v107
    v_exp_f32 v108, v108
    v_cvt_pk_bf16_f32 v125, v106, v107
    v_exp_f32 v109, v109
    v_exp_f32 v110, v110
    v_exp_f32 v111, v111
    v_cvt_pk_bf16_f32 v126, v108, v109
    v_cvt_pk_bf16_f32 v127, v110, v111
    v_mfma_f32_32x32x16_bf16 v[96:111], v[128:131], v[12:15], v[32:47]
    ds_read_b128 v[128:131], v2 offset:12288
    v_exp_f32 v80, v80
    v_exp_f32 v81, v81
    v_exp_f32 v82, v82
    v_mfma_f32_32x32x16_bf16 v[64:79], v[136:139], v[120:123], v[64:79]
    ds_read_b128 v[136:139], v3 offset:9216
    v_exp_f32 v83, v83
    v_exp_f32 v84, v84
    v_exp_f32 v85, v85
    v_mfma_f32_32x32x16_bf16 v[64:79], v[140:143], v[124:127], v[64:79]
    ds_read_b128 v[140:143], v3 offset:9472
    v_cvt_pk_bf16_f32 v112, v80, v81
    v_cvt_pk_bf16_f32 v113, v82, v83
    v_cvt_pk_bf16_f32 v114, v84, v85
    v_exp_f32 v86, v86
    v_exp_f32 v87, v87
    v_exp_f32 v88, v88
    v_cvt_pk_bf16_f32 v115, v86, v87
    v_exp_f32 v89, v89
    v_exp_f32 v90, v90
    v_cvt_pk_bf16_f32 v116, v88, v89
    v_exp_f32 v91, v91
    v_exp_f32 v92, v92
    v_cvt_pk_bf16_f32 v117, v90, v91
    v_exp_f32 v93, v93
    v_exp_f32 v94, v94
    v_exp_f32 v95, v95
    v_cvt_pk_bf16_f32 v118, v92, v93
    v_cvt_pk_bf16_f32 v119, v94, v95
    v_mfma_f32_32x32x16_bf16 v[80:95], v[132:135], v[8:11], v[16:31]
    s_waitcnt lgkmcnt(1)
    v_exp_f32 v96, v96
    v_exp_f32 v97, v97
    v_exp_f32 v98, v98
    v_mfma_f32_32x32x16_bf16 v[48:63], v[136:139], v[112:115], v[48:63]
    s_waitcnt lgkmcnt(0)
    v_exp_f32 v99, v99
    v_exp_f32 v100, v100
    v_exp_f32 v101, v101
    v_mfma_f32_32x32x16_bf16 v[48:63], v[140:143], v[116:119], v[48:63]
    v_cvt_pk_bf16_f32 v120, v96, v97
    v_cvt_pk_bf16_f32 v121, v98, v99
    v_cvt_pk_bf16_f32 v122, v100, v101
    v_exp_f32 v102, v102
    v_exp_f32 v103, v103
    v_exp_f32 v104, v104
    v_cvt_pk_bf16_f32 v123, v102, v103
    v_exp_f32 v105, v105
    v_exp_f32 v106, v106
    v_cvt_pk_bf16_f32 v124, v104, v105
    v_exp_f32 v107, v107
    v_exp_f32 v108, v108
    v_cvt_pk_bf16_f32 v125, v106, v107
    v_exp_f32 v109, v109
    v_exp_f32 v110, v110
    v_exp_f32 v111, v111
    v_cvt_pk_bf16_f32 v126, v108, v109
    v_cvt_pk_bf16_f32 v127, v110, v111
    v_mfma_f32_32x32x16_bf16 v[96:111], v[132:135], v[12:15], v[32:47]
    ds_read_b128 v[132:135], v2 offset:14336
    v_exp_f32 v80, v80
    v_exp_f32 v81, v81
    v_exp_f32 v82, v82
    v_mfma_f32_32x32x16_bf16 v[64:79], v[136:139], v[120:123], v[64:79]
    ds_read_b128 v[136:139], v3 offset:11264
    v_exp_f32 v83, v83
    v_exp_f32 v84, v84
    v_exp_f32 v85, v85
    v_mfma_f32_32x32x16_bf16 v[64:79], v[140:143], v[124:127], v[64:79]
    ds_read_b128 v[140:143], v3 offset:11520
    v_cvt_pk_bf16_f32 v112, v80, v81
    v_cvt_pk_bf16_f32 v113, v82, v83
    v_cvt_pk_bf16_f32 v114, v84, v85
    v_exp_f32 v86, v86
    v_exp_f32 v87, v87
    v_exp_f32 v88, v88
    v_cvt_pk_bf16_f32 v115, v86, v87
    v_exp_f32 v89, v89
    v_exp_f32 v90, v90
    v_cvt_pk_bf16_f32 v116, v88, v89
    v_exp_f32 v91, v91
    v_exp_f32 v92, v92
    v_cvt_pk_bf16_f32 v117, v90, v91
    v_exp_f32 v93, v93
    v_exp_f32 v94, v94
    v_exp_f32 v95, v95
    v_cvt_pk_bf16_f32 v118, v92, v93
    v_cvt_pk_bf16_f32 v119, v94, v95
    v_mfma_f32_32x32x16_bf16 v[80:95], v[128:131], v[8:11], v[16:31]
    s_waitcnt lgkmcnt(1)
    v_exp_f32 v96, v96
    v_exp_f32 v97, v97
    v_exp_f32 v98, v98
    v_mfma_f32_32x32x16_bf16 v[48:63], v[136:139], v[112:115], v[48:63]
    s_waitcnt lgkmcnt(0)
    v_exp_f32 v99, v99
    v_exp_f32 v100, v100
    v_exp_f32 v101, v101
    v_mfma_f32_32x32x16_bf16 v[48:63], v[140:143], v[116:119], v[48:63]
    s_add_u32 s50, s50, 1
    v_cvt_pk_bf16_f32 v120, v96, v97
    v_cvt_pk_bf16_f32 v121, v98, v99
    v_cvt_pk_bf16_f32 v122, v100, v101
    v_exp_f32 v102, v102
    v_exp_f32 v103, v103
    v_exp_f32 v104, v104
    v_cvt_pk_bf16_f32 v123, v102, v103
    v_exp_f32 v105, v105
    v_exp_f32 v106, v106
    v_cvt_pk_bf16_f32 v124, v104, v105
    v_exp_f32 v107, v107
    v_exp_f32 v108, v108
    v_cvt_pk_bf16_f32 v125, v106, v107
    v_exp_f32 v109, v109
    v_exp_f32 v110, v110
    v_exp_f32 v111, v111
    v_cvt_pk_bf16_f32 v126, v108, v109
    v_cvt_pk_bf16_f32 v127, v110, v111
    v_mfma_f32_32x32x16_bf16 v[96:111], v[128:131], v[12:15], v[32:47]
    ds_read_b128 v[128:131], v2 offset:16384
    v_exp_f32 v80, v80
    v_exp_f32 v81, v81
    v_exp_f32 v82, v82
    v_mfma_f32_32x32x16_bf16 v[64:79], v[136:139], v[120:123], v[64:79]
    ds_read_b128 v[136:139], v3 offset:13312
    v_exp_f32 v83, v83
    v_exp_f32 v84, v84
    v_exp_f32 v85, v85
    v_mfma_f32_32x32x16_bf16 v[64:79], v[140:143], v[124:127], v[64:79]
    ds_read_b128 v[140:143], v3 offset:13568
    v_cvt_pk_bf16_f32 v112, v80, v81
    v_cvt_pk_bf16_f32 v113, v82, v83
    v_cvt_pk_bf16_f32 v114, v84, v85
    v_exp_f32 v86, v86
    v_exp_f32 v87, v87
    v_exp_f32 v88, v88
    v_cvt_pk_bf16_f32 v115, v86, v87
    v_exp_f32 v89, v89
    v_exp_f32 v90, v90
    v_cvt_pk_bf16_f32 v116, v88, v89
    v_exp_f32 v91, v91
    v_exp_f32 v92, v92
    v_cvt_pk_bf16_f32 v117, v90, v91
    v_exp_f32 v93, v93
    v_exp_f32 v94, v94
    v_exp_f32 v95, v95
    v_cvt_pk_bf16_f32 v118, v92, v93
    v_cvt_pk_bf16_f32 v119, v94, v95
    v_mfma_f32_32x32x16_bf16 v[80:95], v[132:135], v[8:11], v[16:31]
    s_waitcnt lgkmcnt(1)
    v_exp_f32 v96, v96
    v_exp_f32 v97, v97
    v_exp_f32 v98, v98
    v_mfma_f32_32x32x16_bf16 v[48:63], v[136:139], v[112:115], v[48:63]
    s_waitcnt lgkmcnt(0)
    v_exp_f32 v99, v99
    v_exp_f32 v100, v100
    v_exp_f32 v101, v101
    v_mfma_f32_32x32x16_bf16 v[48:63], v[140:143], v[116:119], v[48:63]
    ds_read_b128 v[148:151], v5
    v_cvt_pk_bf16_f32 v120, v96, v97
    v_cvt_pk_bf16_f32 v121, v98, v99
    v_cvt_pk_bf16_f32 v122, v100, v101
    v_exp_f32 v102, v102
    v_exp_f32 v103, v103
    v_exp_f32 v104, v104
    v_cvt_pk_bf16_f32 v123, v102, v103
    v_exp_f32 v105, v105
    v_exp_f32 v106, v106
    v_cvt_pk_bf16_f32 v124, v104, v105
    v_exp_f32 v107, v107
    v_exp_f32 v108, v108
    v_cvt_pk_bf16_f32 v125, v106, v107
    v_exp_f32 v109, v109
    v_exp_f32 v110, v110
    v_exp_f32 v111, v111
    v_cvt_pk_bf16_f32 v126, v108, v109
    v_cvt_pk_bf16_f32 v127, v110, v111
    v_mfma_f32_32x32x16_bf16 v[96:111], v[132:135], v[12:15], v[32:47]
    ds_read_b128 v[132:135], v2 offset:18432
    v_exp_f32 v80, v80
    v_exp_f32 v81, v81
    v_exp_f32 v82, v82
    v_mfma_f32_32x32x16_bf16 v[64:79], v[136:139], v[120:123], v[64:79]
    ds_read_b128 v[136:139], v3 offset:15360
    v_exp_f32 v83, v83
    v_exp_f32 v84, v84
    v_exp_f32 v85, v85
    v_mfma_f32_32x32x16_bf16 v[64:79], v[140:143], v[124:127], v[64:79]
    ds_read_b128 v[140:143], v3 offset:15616
    v_cvt_pk_bf16_f32 v112, v80, v81
    v_cvt_pk_bf16_f32 v113, v82, v83
    v_cvt_pk_bf16_f32 v114, v84, v85
    v_exp_f32 v86, v86
    v_exp_f32 v87, v87
    v_exp_f32 v88, v88
    v_cvt_pk_bf16_f32 v115, v86, v87
    v_exp_f32 v89, v89
    v_exp_f32 v90, v90
    v_cvt_pk_bf16_f32 v116, v88, v89
    v_exp_f32 v91, v91
    v_exp_f32 v92, v92
    v_cvt_pk_bf16_f32 v117, v90, v91
    v_exp_f32 v93, v93
    v_exp_f32 v94, v94
    v_exp_f32 v95, v95
    v_cvt_pk_bf16_f32 v118, v92, v93
    v_cvt_pk_bf16_f32 v119, v94, v95
    v_mfma_f32_32x32x16_bf16 v[80:95], v[128:131], v[8:11], v[16:31]
    s_waitcnt lgkmcnt(1)
    v_exp_f32 v96, v96
    v_exp_f32 v97, v97
    v_exp_f32 v98, v98
    v_mfma_f32_32x32x16_bf16 v[48:63], v[136:139], v[112:115], v[48:63]
    s_waitcnt lgkmcnt(0)
    v_exp_f32 v99, v99
    v_exp_f32 v100, v100
    v_exp_f32 v101, v101
    v_mfma_f32_32x32x16_bf16 v[48:63], v[140:143], v[116:119], v[48:63]
    v_add_u32 v2, 16384, v2
    v_add_u32 v3, v4, v3
    v_min3_u32 v148, v148, v149, v150
    v_min_u32 v148, v148, v151
    v_cmp_lt_u32 vcc, s50, v148
    v_cvt_pk_bf16_f32 v120, v96, v97
    v_cvt_pk_bf16_f32 v121, v98, v99
    v_cvt_pk_bf16_f32 v122, v100, v101
    v_exp_f32 v102, v102
    v_exp_f32 v103, v103
    v_exp_f32 v104, v104
    v_cvt_pk_bf16_f32 v123, v102, v103
    v_exp_f32 v105, v105
    v_exp_f32 v106, v106
    v_cvt_pk_bf16_f32 v124, v104, v105
    v_exp_f32 v107, v107
    v_exp_f32 v108, v108
    v_cvt_pk_bf16_f32 v125, v106, v107
    v_exp_f32 v109, v109
    v_exp_f32 v110, v110
    v_exp_f32 v111, v111
    v_cvt_pk_bf16_f32 v126, v108, v109
    v_cvt_pk_bf16_f32 v127, v110, v111
    s_cbranch_vccnz LA_loop
    s_cmp_eq_u32 s50, 8
    s_cbranch_scc1 LA_fini
    s_mov_b32 s47, 0
LA_kvw:
    ds_read_b128 v[148:151], v5
    s_add_u32 s47, s47, 1
    s_waitcnt lgkmcnt(0)
    v_min3_u32 v148, v148, v149, v150
    v_min_u32 v148, v148, v151
    v_cmp_lt_u32 vcc, s50, v148
    s_cbranch_vccnz LA_loop
    s_cmp_lt_u32 s47, 4194304
    s_cbranch_scc1 LA_kvw
    s_branch LA_loop
LA_fini:
    v_mfma_f32_32x32x16_bf16 v[64:79], v[136:139], v[120:123], v[64:79]
    v_mfma_f32_32x32x16_bf16 v[64:79], v[140:143], v[124:127], v[64:79]
LA_fin:
    v_rcp_f32 v88, v56
    v_add_f32 v89, |v48|, |v49|
    v_add_f32 v90, |v50|, |v51|
    v_add_f32 v91, |v52|, |v53|
    v_add_f32 v92, |v54|, |v55|
    v_cmp_gt_f32 s[60:61], s56, v56
    v_add_f32 v89, v89, v90
    v_add_f32 v91, v91, v92
    v_mul_f32 v80, v48, v88
    v_add_f32 v89, v89, v91
    v_mul_f32 v81, v49, v88
    v_cmp_gt_f32 vcc, s54, v89
    v_cmp_lt_f32 s[58:59], s55, v89
    v_mul_f32 v82, v50, v88
    v_mul_f32 v83, v51, v88
    v_mul_f32 v84, v52, v88
    v_mul_f32 v85, v53, v88
    v_mul_f32 v86, v54, v88
    v_mul_f32 v87, v55, v88
    s_and_b64 vcc, vcc, s[60:61]
    v_cvt_pk_bf16_f32 v112, v80, v81
    v_cvt_pk_bf16_f32 v113, v82, v83
    v_cvt_pk_bf16_f32 v114, v84, v85
    v_cvt_pk_bf16_f32 v115, v86, v87
    s_and_b64 vcc, vcc, s[58:59]
    v_min_u32 v112, -2, v112
    s_cmp_eq_u64 vcc, -1
    s_cbranch_scc0 LA_fallback
    buffer_store_dwordx4 v[112:115], v1, s[32:35], s66 offen sc1
LA_finb:
    v_rcp_f32 v104, v72
    v_add_f32 v105, |v64|, |v65|
    v_add_f32 v106, |v66|, |v67|
    v_add_f32 v107, |v68|, |v69|
    v_add_f32 v108, |v70|, |v71|
    v_cmp_gt_f32 s[60:61], s56, v72
    v_add_f32 v105, v105, v106
    v_add_f32 v107, v107, v108
    v_mul_f32 v96, v64, v104
    v_add_f32 v105, v105, v107
    v_mul_f32 v97, v65, v104
    v_cmp_gt_f32 vcc, s54, v105
    v_cmp_lt_f32 s[58:59], s55, v105
    v_mul_f32 v98, v66, v104
    v_mul_f32 v99, v67, v104
    v_mul_f32 v100, v68, v104
    v_mul_f32 v101, v69, v104
    v_mul_f32 v102, v70, v104
    v_mul_f32 v103, v71, v104
    s_and_b64 vcc, vcc, s[60:61]
    v_cvt_pk_bf16_f32 v120, v96, v97
    v_cvt_pk_bf16_f32 v121, v98, v99
    v_cvt_pk_bf16_f32 v122, v100, v101
    v_cvt_pk_bf16_f32 v123, v102, v103
    s_and_b64 vcc, vcc, s[58:59]
    v_min_u32 v120, -2, v120
    s_cmp_eq_u64 vcc, -1
    s_cbranch_scc0 LA_fallb
    buffer_store_dwordx4 v[120:123], v1, s[32:35], s67 offen sc1
LA_done:
    s_barrier
    s_endpgm
LA_fallb:
    s_mov_b32 s57, 1
    s_mov_b32 s66, s67
    v_mov_b64 v[8:9], v[12:13]
    v_mov_b64 v[10:11], v[14:15]
LA_fallback:
    v_mov_b32 v16, 0xff800000
    v_mov_b32 v2, v1
    s_mov_b32 s50, 0
LA_fb1:
    ds_read_b128 v[128:131], v2
    v_add_u32 v2, 0x800, v2
    s_waitcnt lgkmcnt(0)
    v_mfma_f32_32x32x16_bf16 v[80:95], v[128:131], v[8:11], 0
    s_nop 11
    v_max3_f32 v16, v16, v80, v81
    v_max3_f32 v16, v16, v82, v83
    v_max3_f32 v16, v16, v84, v85
    v_max3_f32 v16, v16, v86, v87
    v_max3_f32 v16, v16, v88, v89
    v_max3_f32 v16, v16, v90, v91
    v_max3_f32 v16, v16, v92, v93
    v_max3_f32 v16, v16, v94, v95
    s_add_u32 s50, s50, 1
    s_cmp_lt_u32 s50, 64
    s_cbranch_scc1 LA_fb1
    v_mov_b32 v17, v16
    v_cmp_eq_u32 vcc, 0, v4
    v_lshrrev_b32 v6, 3, v4
    v_permlane32_swap_b32 v16, v17
    v_max_f32 v16, v16, v17
    v_sub_f32 v16, 0, v16
    v_cndmask_b32 v3, v1, v3, vcc
    v_mov_b32 v17, v16
    v_mov_b32 v18, v16
    v_mov_b32 v19, v16
    v_mov_b32 v20, v16
    v_mov_b32 v21, v16
    v_mov_b32 v22, v16
    v_mov_b32 v23, v16
    v_mov_b32 v24, v16
    v_mov_b32 v25, v16
    v_mov_b32 v26, v16
    v_mov_b32 v27, v16
    v_mov_b32 v28, v16
    v_mov_b32 v29, v16
    v_mov_b32 v30, v16
    v_mov_b32 v31, v16
    v_mov_b64 v[48:49], 0
    v_mov_b64 v[50:51], 0
    v_mov_b64 v[52:53], 0
    v_mov_b64 v[54:55], 0
    v_mov_b64 v[56:57], 0
    v_mov_b64 v[58:59], 0
    v_mov_b64 v[60:61], 0
    v_mov_b64 v[62:63], 0
    v_mov_b32 v2, v1
    s_mov_b32 s50, 0
LA_fb2:
    ds_read_b128 v[128:131], v2
    ds_read_b128 v[136:139], v3 offset:1024
    ds_read_b128 v[140:143], v3 offset:1280
    v_add_u32 v2, 0x800, v2
    v_add_u32 v3, v6, v3
    s_waitcnt lgkmcnt(0)
    v_mfma_f32_32x32x16_bf16 v[80:95], v[128:131], v[8:11], v[16:31]
    s_nop 11
    v_exp_f32 v80, v80
    v_exp_f32 v81, v81
    v_exp_f32 v82, v82
    v_exp_f32 v83, v83
    v_exp_f32 v84, v84
    v_exp_f32 v85, v85
    v_exp_f32 v86, v86
    v_exp_f32 v87, v87
    v_exp_f32 v88, v88
    v_exp_f32 v89, v89
    v_exp_f32 v90, v90
    v_exp_f32 v91, v91
    v_exp_f32 v92, v92
    v_exp_f32 v93, v93
    v_exp_f32 v94, v94
    v_exp_f32 v95, v95
    s_nop 0
    v_cvt_pk_bf16_f32 v112, v80, v81
    v_cvt_pk_bf16_f32 v113, v82, v83
    v_cvt_pk_bf16_f32 v114, v84, v85
    v_cvt_pk_bf16_f32 v115, v86, v87
    v_cvt_pk_bf16_f32 v116, v88, v89
    v_cvt_pk_bf16_f32 v117, v90, v91
    v_cvt_pk_bf16_f32 v118, v92, v93
    v_cvt_pk_bf16_f32 v119, v94, v95
    s_nop 1
    v_mfma_f32_32x32x16_bf16 v[48:63], v[136:139], v[112:115], v[48:63]
    v_mfma_f32_32x32x16_bf16 v[48:63], v[140:143], v[116:119], v[48:63]
    s_add_u32 s50, s50, 1
    s_cmp_lt_u32 s50, 64
    s_cbranch_scc1 LA_fb2
    s_nop 11
    v_rcp_f32 v56, v56
    s_nop 0
    v_mul_f32 v48, v48, v56
    v_mul_f32 v49, v49, v56
    v_mul_f32 v50, v50, v56
    v_mul_f32 v51, v51, v56
    v_mul_f32 v52, v52, v56
    v_mul_f32 v53, v53, v56
    v_mul_f32 v54, v54, v56
    v_mul_f32 v55, v55, v56
    v_cvt_pk_bf16_f32 v112, v48, v49
    v_cvt_pk_bf16_f32 v113, v50, v51
    v_cvt_pk_bf16_f32 v114, v52, v53
    v_cvt_pk_bf16_f32 v115, v54, v55
    v_min_u32 v112, -2, v112
    buffer_store_dwordx4 v[112:115], v1, s[32:35], s66 offen sc1
    s_cmp_eq_u32 s57, 1
    s_cbranch_scc1 LA_done
    s_branch LA_finb
LC_Bv:
    s_waitcnt lgkmcnt(0)
    v_mfma_f32_32x32x16_bf16 v[192:207], v[32:35], v[40:43], v[192:207]
    ds_read_b128 v[20:23], v4 offset:49952
    ds_read_b128 v[24:27], v4 offset:50080
    ds_read_b64_tr_b16 v[12:13], v62 offset:51712
    v_mul_f32 v128, v85, v128
    v_mul_f32 v129, v85, v129
    v_mul_f32 v130, v85, v130
    v_mfma_f32_32x32x16_bf16 v[208:223], v[32:35], v[44:47], v[208:223]
    ds_read_b64_tr_b16 v[14:15], v62 offset:51840
    ds_read_b64_tr_b16 v[16:17], v62 offset:51744
    ds_read_b64_tr_b16 v[18:19], v62 offset:51872
    v_mul_f32 v131, v85, v131
    v_mul_f32 v132, v85, v132
    v_mul_f32 v133, v85, v133
    v_mfma_f32_32x32x16_bf16 v[224:239], v[36:39], v[40:43], v[224:239]
    v_mul_f32 v134, v85, v134
    v_mul_f32 v135, v85, v135
    v_mul_f32 v136, v85, v136
    v_mul_f32 v137, v85, v137
    v_mul_f32 v138, v85, v138
    v_mul_f32 v139, v85, v139
    v_mfma_f32_32x32x16_bf16 v[240:255], v[36:39], v[44:47], v[240:255]
    v_mul_f32 v140, v85, v140
    v_mul_f32 v141, v85, v141
    v_mul_f32 v142, v85, v142
    v_mul_f32 v143, v85, v143
    v_cvt_pk_bf16_f32 v128, v128, v129
    v_cvt_pk_bf16_f32 v129, v130, v131
    s_waitcnt lgkmcnt(0)
    s_barrier
    v_mfma_f32_32x32x16_bf16 v[192:207], v[12:15], v[20:23], v[192:207]
    ds_read_b128 v[40:43], v4 offset:49984
    ds_read_b128 v[44:47], v4 offset:50112
    ds_read_b64_tr_b16 v[32:33], v62 offset:64000
    v_cvt_pk_bf16_f32 v130, v132, v133
    v_cvt_pk_bf16_f32 v131, v134, v135
    v_cvt_pk_bf16_f32 v132, v136, v137
    v_mfma_f32_32x32x16_bf16 v[208:223], v[12:15], v[24:27], v[208:223]
    ds_read_b64_tr_b16 v[34:35], v62 offset:64128
    ds_read_b64_tr_b16 v[36:37], v62 offset:64032
    ds_read_b64_tr_b16 v[38:39], v62 offset:64160
    v_cvt_pk_bf16_f32 v133, v138, v139
    v_cvt_pk_bf16_f32 v134, v140, v141
    v_cvt_pk_bf16_f32 v135, v142, v143
    v_mfma_f32_32x32x16_bf16 v[224:239], v[16:19], v[20:23], v[224:239]
    ds_write2_b64 v75, v[128:129], v[130:131] offset0:0 offset1:72
    ds_write2_b64 v75, v[132:133], v[134:135] offset0:144 offset1:216
    ds_read_b64_tr_b16 v[136:137], v76 offset:0
    ds_read_b64_tr_b16 v[138:139], v76 offset:64
    ds_read_b64_tr_b16 v[140:141], v76 offset:1152
    ds_read_b64_tr_b16 v[142:143], v76 offset:1216
    v_mfma_f32_32x32x16_bf16 v[240:255], v[16:19], v[24:27], v[240:255]
    v_mul_f32 v112, v91, v112
    v_mul_f32 v113, v91, v113
    v_mul_f32 v114, v91, v114
    v_mul_f32 v115, v91, v115
    v_mul_f32 v116, v91, v116
    v_mul_f32 v117, v91, v117
    s_waitcnt lgkmcnt(6)
    v_mfma_f32_32x32x16_bf16 v[192:207], v[32:35], v[40:43], v[192:207]
    ds_read_b128 v[20:23], v4 offset:50016
    ds_read_b128 v[24:27], v4 offset:50144
    ds_read_b64_tr_b16 v[12:13], v62 offset:64512
    v_mul_f32 v118, v91, v118
    v_mul_f32 v119, v91, v119
    v_cvt_pk_bf16_f32 v112, v112, v113
    v_mfma_f32_32x32x16_bf16 v[208:223], v[32:35], v[44:47], v[208:223]
    ds_read_b64_tr_b16 v[14:15], v62 offset:64640
    ds_read_b64_tr_b16 v[16:17], v62 offset:64544
    ds_read_b64_tr_b16 v[18:19], v62 offset:64672
    v_cvt_pk_bf16_f32 v113, v114, v115
    v_cvt_pk_bf16_f32 v114, v116, v117
    v_cvt_pk_bf16_f32 v115, v118, v119
    v_mfma_f32_32x32x16_bf16 v[224:239], v[36:39], v[40:43], v[224:239]
    v_mul_f32 v160, v85, v160
    v_mul_f32 v161, v85, v161
    v_mul_f32 v162, v85, v162
    v_mul_f32 v163, v85, v163
    v_mul_f32 v164, v85, v164
    v_mul_f32 v165, v85, v165
    v_mfma_f32_32x32x16_bf16 v[240:255], v[36:39], v[44:47], v[240:255]
    buffer_store_dwordx4 v[112:115], v63, s[32:35], s64 offen sc1
    v_mul_f32 v166, v85, v166
    v_mul_f32 v167, v85, v167
    v_mul_f32 v168, v85, v168
    s_waitcnt lgkmcnt(0)
    s_barrier
    v_mfma_f32_32x32x16_bf16 v[192:207], v[12:15], v[20:23], v[192:207]
    ds_read_b128 v[40:43], v4 offset:33280
    ds_read_b128 v[44:47], v4 offset:33408
    ds_read_b64_tr_b16 v[32:33], v62 offset:25600
    v_mul_f32 v169, v85, v169
    v_mul_f32 v170, v85, v170
    v_mul_f32 v171, v85, v171
    v_mfma_f32_32x32x16_bf16 v[208:223], v[12:15], v[24:27], v[208:223]
    ds_read_b64_tr_b16 v[34:35], v62 offset:25728
    ds_read_b64_tr_b16 v[36:37], v62 offset:25632
    ds_read_b64_tr_b16 v[38:39], v62 offset:25760
    v_mul_f32 v172, v85, v172
    v_mul_f32 v173, v85, v173
    v_mul_f32 v174, v85, v174
    v_mfma_f32_32x32x16_bf16 v[224:239], v[16:19], v[20:23], v[224:239]
    v_mul_f32 v175, v85, v175
    v_cvt_pk_bf16_f32 v160, v160, v161
    v_cvt_pk_bf16_f32 v161, v162, v163
    v_cvt_pk_bf16_f32 v162, v164, v165
    v_cvt_pk_bf16_f32 v163, v166, v167
    v_cvt_pk_bf16_f32 v164, v168, v169
    v_mfma_f32_32x32x16_bf16 v[240:255], v[16:19], v[24:27], v[240:255]
    buffer_store_dwordx4 v[136:139], v63, s[32:35], s8 offen offset:1024 sc1
    v_cvt_pk_bf16_f32 v165, v170, v171
    v_cvt_pk_bf16_f32 v166, v172, v173
    v_cvt_pk_bf16_f32 v167, v174, v175
    s_waitcnt lgkmcnt(0)
    v_mfma_f32_32x32x16_bf16 v[192:207], v[32:35], v[40:43], v[192:207]
    ds_read_b128 v[20:23], v4 offset:33312
    ds_read_b128 v[24:27], v4 offset:33440
    ds_read_b64_tr_b16 v[12:13], v62 offset:26112
    v_mul_f32 v120, v91, v120
    v_mul_f32 v121, v91, v121
    v_mul_f32 v122, v91, v122
    v_mfma_f32_32x32x16_bf16 v[208:223], v[32:35], v[44:47], v[208:223]
    ds_read_b64_tr_b16 v[14:15], v62 offset:26240
    ds_read_b64_tr_b16 v[16:17], v62 offset:26144
    ds_read_b64_tr_b16 v[18:19], v62 offset:26272
    v_mul_f32 v123, v91, v123
    v_mul_f32 v124, v91, v124
    v_mul_f32 v125, v91, v125
    v_mfma_f32_32x32x16_bf16 v[224:239], v[36:39], v[40:43], v[224:239]
    ds_write2_b64 v75, v[160:161], v[162:163] offset0:0 offset1:72
    ds_write2_b64 v75, v[164:165], v[166:167] offset0:144 offset1:216
    ds_read_b64_tr_b16 v[168:169], v76 offset:0
    ds_read_b64_tr_b16 v[170:171], v76 offset:64
    ds_read_b64_tr_b16 v[172:173], v76 offset:1152
    ds_read_b64_tr_b16 v[174:175], v76 offset:1216
    v_mfma_f32_32x32x16_bf16 v[240:255], v[36:39], v[44:47], v[240:255]
    buffer_store_dwordx4 v[140:143], v63, s[32:35], s9 offen offset:1024 sc1
    v_mul_f32 v126, v91, v126
    v_mul_f32 v127, v91, v127
    v_cvt_pk_bf16_f32 v120, v120, v121
    s_waitcnt lgkmcnt(6)
    s_barrier
    v_mfma_f32_32x32x16_bf16 v[192:207], v[12:15], v[20:23], v[192:207]
    ds_read_b128 v[40:43], v4 offset:33344
    ds_read_b128 v[44:47], v4 offset:33472
    ds_read_b64_tr_b16 v[32:33], v62 offset:38400
    v_cvt_pk_bf16_f32 v121, v122, v123
    v_cvt_pk_bf16_f32 v122, v124, v125
    v_cvt_pk_bf16_f32 v123, v126, v127
    v_mfma_f32_32x32x16_bf16 v[208:223], v[12:15], v[24:27], v[208:223]
    ds_read_b64_tr_b16 v[34:35], v62 offset:38528
    ds_read_b64_tr_b16 v[36:37], v62 offset:38432
    ds_read_b64_tr_b16 v[38:39], v62 offset:38560
    v_mfma_f32_32x32x16_bf16 v[224:239], v[16:19], v[20:23], v[224:239]
    v_mfma_f32_32x32x16_bf16 v[240:255], v[16:19], v[24:27], v[240:255]
    buffer_store_dwordx4 v[120:123], v63, s[32:35], s65 offen sc1
    s_waitcnt lgkmcnt(0)
    v_mfma_f32_32x32x16_bf16 v[192:207], v[32:35], v[40:43], v[192:207]
    ds_read_b128 v[20:23], v4 offset:33376
    ds_read_b128 v[24:27], v4 offset:33504
    ds_read_b64_tr_b16 v[12:13], v62 offset:38912
    v_mfma_f32_32x32x16_bf16 v[208:223], v[32:35], v[44:47], v[208:223]
    ds_read_b64_tr_b16 v[14:15], v62 offset:39040
    ds_read_b64_tr_b16 v[16:17], v62 offset:38944
    ds_read_b64_tr_b16 v[18:19], v62 offset:39072
    v_mfma_f32_32x32x16_bf16 v[224:239], v[36:39], v[40:43], v[224:239]
    v_mfma_f32_32x32x16_bf16 v[240:255], v[36:39], v[44:47], v[240:255]
    buffer_store_dwordx4 v[168:171], v63, s[32:35], s10 offen offset:1024 sc1
    s_waitcnt lgkmcnt(0)
    s_barrier
    v_mfma_f32_32x32x16_bf16 v[192:207], v[12:15], v[20:23], v[192:207]
    ds_read_b128 v[40:43], v4 offset:16640
    ds_read_b128 v[44:47], v4 offset:16768
    ds_read_b64_tr_b16 v[32:33], v62 offset:0
    v_mfma_f32_32x32x16_bf16 v[208:223], v[12:15], v[24:27], v[208:223]
    ds_read_b64_tr_b16 v[34:35], v62 offset:128
    ds_read_b64_tr_b16 v[36:37], v62 offset:32
    ds_read_b64_tr_b16 v[38:39], v62 offset:160
    v_mfma_f32_32x32x16_bf16 v[224:239], v[16:19], v[20:23], v[224:239]
    v_mfma_f32_32x32x16_bf16 v[240:255], v[16:19], v[24:27], v[240:255]
    buffer_store_dwordx4 v[172:175], v63, s[32:35], s11 offen offset:1024 sc1
    s_waitcnt lgkmcnt(0)
    v_mfma_f32_32x32x16_bf16 v[192:207], v[32:35], v[40:43], v[192:207]
    ds_read_b128 v[20:23], v4 offset:16672
    ds_read_b128 v[24:27], v4 offset:16800
    ds_read_b64_tr_b16 v[12:13], v62 offset:512
    v_mfma_f32_32x32x16_bf16 v[208:223], v[32:35], v[44:47], v[208:223]
    ds_read_b64_tr_b16 v[14:15], v62 offset:640
    ds_read_b64_tr_b16 v[16:17], v62 offset:544
    ds_read_b64_tr_b16 v[18:19], v62 offset:672
    v_mfma_f32_32x32x16_bf16 v[224:239], v[36:39], v[40:43], v[224:239]
    v_mfma_f32_32x32x16_bf16 v[240:255], v[36:39], v[44:47], v[240:255]
    s_waitcnt lgkmcnt(0)
    s_barrier
    v_mfma_f32_32x32x16_bf16 v[192:207], v[12:15], v[20:23], v[192:207]
    ds_read_b128 v[40:43], v4 offset:16704
    ds_read_b128 v[44:47], v4 offset:16832
    ds_read_b64_tr_b16 v[32:33], v62 offset:12800
    v_mfma_f32_32x32x16_bf16 v[208:223], v[12:15], v[24:27], v[208:223]
    ds_read_b64_tr_b16 v[34:35], v62 offset:12928
    ds_read_b64_tr_b16 v[36:37], v62 offset:12832
    ds_read_b64_tr_b16 v[38:39], v62 offset:12960
    v_mfma_f32_32x32x16_bf16 v[224:239], v[16:19], v[20:23], v[224:239]
    v_mfma_f32_32x32x16_bf16 v[240:255], v[16:19], v[24:27], v[240:255]
    s_waitcnt lgkmcnt(0)
    v_mfma_f32_32x32x16_bf16 v[192:207], v[32:35], v[40:43], v[192:207]
    ds_read_b128 v[20:23], v4 offset:16736
    ds_read_b128 v[24:27], v4 offset:16864
    ds_read_b64_tr_b16 v[12:13], v62 offset:13312
    v_mfma_f32_32x32x16_bf16 v[208:223], v[32:35], v[44:47], v[208:223]
    ds_read_b64_tr_b16 v[14:15], v62 offset:13440
    ds_read_b64_tr_b16 v[16:17], v62 offset:13344
    ds_read_b64_tr_b16 v[18:19], v62 offset:13472
    v_mfma_f32_32x32x16_bf16 v[224:239], v[36:39], v[40:43], v[224:239]
    v_mfma_f32_32x32x16_bf16 v[240:255], v[36:39], v[44:47], v[240:255]
    s_waitcnt lgkmcnt(0)
    s_barrier
    v_mfma_f32_32x32x16_bf16 v[192:207], v[12:15], v[20:23], v[192:207]
    ds_read_b128 v[40:43], v4 offset:0
    ds_read_b128 v[44:47], v4 offset:128
    ds_read_b64_tr_b16 v[32:33], v62 offset:51200
    v_mul_f32 v144, v93, v144
    v_mul_f32 v145, v93, v145
    v_mul_f32 v146, v93, v146
    v_mfma_f32_32x32x16_bf16 v[208:223], v[12:15], v[24:27], v[208:223]
    ds_read_b64_tr_b16 v[34:35], v62 offset:51328
    ds_read_b64_tr_b16 v[36:37], v62 offset:51232
    ds_read_b64_tr_b16 v[38:39], v62 offset:51360
    v_mul_f32 v147, v93, v147
    v_mul_f32 v148, v93, v148
    v_mul_f32 v149, v93, v149
    v_mfma_f32_32x32x16_bf16 v[224:239], v[16:19], v[20:23], v[224:239]
    v_mul_f32 v150, v93, v150
    v_mul_f32 v151, v93, v151
    v_mul_f32 v152, v93, v152
    v_mul_f32 v153, v93, v153
    v_mul_f32 v154, v93, v154
    v_mul_f32 v155, v93, v155
    v_mfma_f32_32x32x16_bf16 v[240:255], v[16:19], v[24:27], v[240:255]
    v_mul_f32 v156, v93, v156
    v_mul_f32 v157, v93, v157
    v_mul_f32 v158, v93, v158
    v_mul_f32 v159, v93, v159
    v_cvt_pk_bf16_f32 v144, v144, v145
    v_cvt_pk_bf16_f32 v145, v146, v147
    s_waitcnt lgkmcnt(0)
    v_mfma_f32_32x32x16_bf16 v[192:207], v[32:35], v[40:43], v[192:207]
    ds_read_b128 v[20:23], v4 offset:32
    ds_read_b128 v[24:27], v4 offset:160
    ds_read_b64_tr_b16 v[12:13], v62 offset:51712
    v_cvt_pk_bf16_f32 v146, v148, v149
    v_cvt_pk_bf16_f32 v147, v150, v151
    v_cvt_pk_bf16_f32 v148, v152, v153
    v_mfma_f32_32x32x16_bf16 v[208:223], v[32:35], v[44:47], v[208:223]
    ds_read_b64_tr_b16 v[14:15], v62 offset:51840
    ds_read_b64_tr_b16 v[16:17], v62 offset:51744
    ds_read_b64_tr_b16 v[18:19], v62 offset:51872
    v_cvt_pk_bf16_f32 v149, v154, v155
    v_cvt_pk_bf16_f32 v150, v156, v157
    v_cvt_pk_bf16_f32 v151, v158, v159
    v_mfma_f32_32x32x16_bf16 v[224:239], v[36:39], v[40:43], v[224:239]
    v_mul_f32 v176, v93, v176
    v_mul_f32 v177, v93, v177
    v_mul_f32 v178, v93, v178
    v_mul_f32 v179, v93, v179
    v_mul_f32 v180, v93, v180
    v_mul_f32 v181, v93, v181
    v_mfma_f32_32x32x16_bf16 v[240:255], v[36:39], v[44:47], v[240:255]
    v_mul_f32 v182, v93, v182
    v_mul_f32 v183, v93, v183
    v_mul_f32 v184, v93, v184
    v_mul_f32 v185, v93, v185
    v_mul_f32 v186, v93, v186
    v_mul_f32 v187, v93, v187
    s_waitcnt lgkmcnt(0) vmcnt(0)
    s_barrier
    v_mfma_f32_32x32x16_bf16 v[192:207], v[12:15], v[20:23], v[192:207]
    ds_read_b128 v[40:43], v4 offset:64
    ds_read_b128 v[44:47], v4 offset:192
    ds_read_b64_tr_b16 v[32:33], v62 offset:64000
    v_mul_f32 v188, v93, v188
    v_mul_f32 v189, v93, v189
    v_mul_f32 v190, v93, v190
    v_mfma_f32_32x32x16_bf16 v[208:223], v[12:15], v[24:27], v[208:223]
    ds_read_b64_tr_b16 v[34:35], v62 offset:64128
    ds_read_b64_tr_b16 v[36:37], v62 offset:64032
    ds_read_b64_tr_b16 v[38:39], v62 offset:64160
    v_mul_f32 v191, v93, v191
    v_cvt_pk_bf16_f32 v176, v176, v177
    v_cvt_pk_bf16_f32 v177, v178, v179
    v_mfma_f32_32x32x16_bf16 v[224:239], v[16:19], v[20:23], v[224:239]
    v_cvt_pk_bf16_f32 v178, v180, v181
    v_cvt_pk_bf16_f32 v179, v182, v183
    v_cvt_pk_bf16_f32 v180, v184, v185
    v_cvt_pk_bf16_f32 v181, v186, v187
    v_cvt_pk_bf16_f32 v182, v188, v189
    v_cvt_pk_bf16_f32 v183, v190, v191
    v_mfma_f32_32x32x16_bf16 v[240:255], v[16:19], v[24:27], v[240:255]
    s_waitcnt lgkmcnt(0)
    v_mfma_f32_32x32x16_bf16 v[192:207], v[32:35], v[40:43], v[192:207]
    ds_read_b128 v[20:23], v4 offset:96
    ds_read_b128 v[24:27], v4 offset:224
    ds_read_b64_tr_b16 v[12:13], v62 offset:64512
    v_mfma_f32_32x32x16_bf16 v[208:223], v[32:35], v[44:47], v[208:223]
    ds_read_b64_tr_b16 v[14:15], v62 offset:64640
    ds_read_b64_tr_b16 v[16:17], v62 offset:64544
    ds_read_b64_tr_b16 v[18:19], v62 offset:64672
    v_mfma_f32_32x32x16_bf16 v[224:239], v[36:39], v[40:43], v[224:239]
    v_mfma_f32_32x32x16_bf16 v[240:255], v[36:39], v[44:47], v[240:255]
    s_waitcnt lgkmcnt(0)
    s_barrier
    v_mfma_f32_32x32x16_bf16 v[192:207], v[12:15], v[20:23], v[192:207]
    ds_read_b128 v[40:43], v4 offset:49920
    ds_read_b128 v[44:47], v4 offset:50048
    ds_read_b64_tr_b16 v[32:33], v62 offset:25600
    v_mfma_f32_32x32x16_bf16 v[208:223], v[12:15], v[24:27], v[208:223]
    ds_read_b64_tr_b16 v[34:35], v62 offset:25728
    ds_read_b64_tr_b16 v[36:37], v62 offset:25632
    ds_read_b64_tr_b16 v[38:39], v62 offset:25760
    v_mfma_f32_32x32x16_bf16 v[224:239], v[16:19], v[20:23], v[224:239]
    v_mfma_f32_32x32x16_bf16 v[240:255], v[16:19], v[24:27], v[240:255]
    s_waitcnt lgkmcnt(0)
    v_mfma_f32_32x32x16_bf16 v[192:207], v[32:35], v[40:43], v[192:207]
    ds_read_b128 v[20:23], v4 offset:49952
    ds_read_b128 v[24:27], v4 offset:50080
    ds_read_b64_tr_b16 v[12:13], v62 offset:26112
    v_mfma_f32_32x32x16_bf16 v[208:223], v[32:35], v[44:47], v[208:223]
    ds_read_b64_tr_b16 v[14:15], v62 offset:26240
    ds_read_b64_tr_b16 v[16:17], v62 offset:26144
    ds_read_b64_tr_b16 v[18:19], v62 offset:26272
    v_mfma_f32_32x32x16_bf16 v[224:239], v[36:39], v[40:43], v[224:239]
    v_mfma_f32_32x32x16_bf16 v[240:255], v[36:39], v[44:47], v[240:255]
    s_waitcnt lgkmcnt(0)
    s_barrier
    v_mfma_f32_32x32x16_bf16 v[192:207], v[12:15], v[20:23], v[192:207]
    ds_read_b128 v[40:43], v4 offset:49984
    ds_read_b128 v[44:47], v4 offset:50112
    ds_read_b64_tr_b16 v[32:33], v62 offset:38400
    v_mfma_f32_32x32x16_bf16 v[208:223], v[12:15], v[24:27], v[208:223]
    ds_read_b64_tr_b16 v[34:35], v62 offset:38528
    ds_read_b64_tr_b16 v[36:37], v62 offset:38432
    ds_read_b64_tr_b16 v[38:39], v62 offset:38560
    v_mfma_f32_32x32x16_bf16 v[224:239], v[16:19], v[20:23], v[224:239]
    v_mfma_f32_32x32x16_bf16 v[240:255], v[16:19], v[24:27], v[240:255]
    s_waitcnt lgkmcnt(0)
    v_mfma_f32_32x32x16_bf16 v[192:207], v[32:35], v[40:43], v[192:207]
    ds_read_b128 v[20:23], v4 offset:50016
    ds_read_b128 v[24:27], v4 offset:50144
    ds_read_b64_tr_b16 v[12:13], v62 offset:38912
    v_mfma_f32_32x32x16_bf16 v[208:223], v[32:35], v[44:47], v[208:223]
    ds_read_b64_tr_b16 v[14:15], v62 offset:39040
    ds_read_b64_tr_b16 v[16:17], v62 offset:38944
    ds_read_b64_tr_b16 v[18:19], v62 offset:39072
    v_mfma_f32_32x32x16_bf16 v[224:239], v[36:39], v[40:43], v[224:239]
    v_mfma_f32_32x32x16_bf16 v[240:255], v[36:39], v[44:47], v[240:255]
    s_waitcnt lgkmcnt(0)
    s_barrier
    v_mfma_f32_32x32x16_bf16 v[192:207], v[12:15], v[20:23], v[192:207]
    ds_read_b128 v[40:43], v4 offset:33280
    ds_read_b128 v[44:47], v4 offset:33408
    ds_read_b64_tr_b16 v[32:33], v62 offset:0
    v_mfma_f32_32x32x16_bf16 v[208:223], v[12:15], v[24:27], v[208:223]
    ds_read_b64_tr_b16 v[34:35], v62 offset:128
    ds_read_b64_tr_b16 v[36:37], v62 offset:32
    ds_read_b64_tr_b16 v[38:39], v62 offset:160
    v_mfma_f32_32x32x16_bf16 v[224:239], v[16:19], v[20:23], v[224:239]
    v_mfma_f32_32x32x16_bf16 v[240:255], v[16:19], v[24:27], v[240:255]
    s_waitcnt lgkmcnt(0)
    v_mfma_f32_32x32x16_bf16 v[192:207], v[32:35], v[40:43], v[192:207]
    ds_read_b128 v[20:23], v4 offset:33312
    ds_read_b128 v[24:27], v4 offset:33440
    ds_read_b64_tr_b16 v[12:13], v62 offset:512
    v_mfma_f32_32x32x16_bf16 v[208:223], v[32:35], v[44:47], v[208:223]
    ds_read_b64_tr_b16 v[14:15], v62 offset:640
    ds_read_b64_tr_b16 v[16:17], v62 offset:544
    ds_read_b64_tr_b16 v[18:19], v62 offset:672
    v_mfma_f32_32x32x16_bf16 v[224:239], v[36:39], v[40:43], v[224:239]
    v_mfma_f32_32x32x16_bf16 v[240:255], v[36:39], v[44:47], v[240:255]
    s_waitcnt lgkmcnt(0)
    s_barrier
    v_mfma_f32_32x32x16_bf16 v[192:207], v[12:15], v[20:23], v[192:207]
    ds_read_b128 v[40:43], v4 offset:33344
    ds_read_b128 v[44:47], v4 offset:33472
    ds_read_b64_tr_b16 v[32:33], v62 offset:12800
    v_mfma_f32_32x32x16_bf16 v[208:223], v[12:15], v[24:27], v[208:223]
    ds_read_b64_tr_b16 v[34:35], v62 offset:12928
    ds_read_b64_tr_b16 v[36:37], v62 offset:12832
    ds_read_b64_tr_b16 v[38:39], v62 offset:12960
    v_mfma_f32_32x32x16_bf16 v[224:239], v[16:19], v[20:23], v[224:239]
    v_mfma_f32_32x32x16_bf16 v[240:255], v[16:19], v[24:27], v[240:255]
    s_waitcnt lgkmcnt(0)
    v_mfma_f32_32x32x16_bf16 v[192:207], v[32:35], v[40:43], v[192:207]
    ds_read_b128 v[20:23], v4 offset:33376
    ds_read_b128 v[24:27], v4 offset:33504
    ds_read_b64_tr_b16 v[12:13], v62 offset:13312
    v_mfma_f32_32x32x16_bf16 v[208:223], v[32:35], v[44:47], v[208:223]
    ds_read_b64_tr_b16 v[14:15], v62 offset:13440
    ds_read_b64_tr_b16 v[16:17], v62 offset:13344
    ds_read_b64_tr_b16 v[18:19], v62 offset:13472
    v_mfma_f32_32x32x16_bf16 v[224:239], v[36:39], v[40:43], v[224:239]
    v_mfma_f32_32x32x16_bf16 v[240:255], v[36:39], v[44:47], v[240:255]
    s_waitcnt lgkmcnt(0)
    s_barrier
    v_mfma_f32_32x32x16_bf16 v[192:207], v[12:15], v[20:23], v[192:207]
    ds_read_b128 v[40:43], v4 offset:16640
    ds_read_b128 v[44:47], v4 offset:16768
    ds_read_b64_tr_b16 v[32:33], v62 offset:51200
    v_mfma_f32_32x32x16_bf16 v[208:223], v[12:15], v[24:27], v[208:223]
    ds_read_b64_tr_b16 v[34:35], v62 offset:51328
    ds_read_b64_tr_b16 v[36:37], v62 offset:51232
    ds_read_b64_tr_b16 v[38:39], v62 offset:51360
    v_mfma_f32_32x32x16_bf16 v[224:239], v[16:19], v[20:23], v[224:239]
    v_mfma_f32_32x32x16_bf16 v[240:255], v[16:19], v[24:27], v[240:255]
    s_waitcnt lgkmcnt(0)
    v_mfma_f32_32x32x16_bf16 v[192:207], v[32:35], v[40:43], v[192:207]
    ds_read_b128 v[20:23], v4 offset:16672
    ds_read_b128 v[24:27], v4 offset:16800
    ds_read_b64_tr_b16 v[12:13], v62 offset:51712
    v_mfma_f32_32x32x16_bf16 v[208:223], v[32:35], v[44:47], v[208:223]
    ds_read_b64_tr_b16 v[14:15], v62 offset:51840
    ds_read_b64_tr_b16 v[16:17], v62 offset:51744
    ds_read_b64_tr_b16 v[18:19], v62 offset:51872
    v_mfma_f32_32x32x16_bf16 v[224:239], v[36:39], v[40:43], v[224:239]
    v_mfma_f32_32x32x16_bf16 v[240:255], v[36:39], v[44:47], v[240:255]
    s_waitcnt lgkmcnt(0)
    s_barrier
    v_mfma_f32_32x32x16_bf16 v[192:207], v[12:15], v[20:23], v[192:207]
    ds_read_b128 v[40:43], v4 offset:16704
    ds_read_b128 v[44:47], v4 offset:16832
    ds_read_b64_tr_b16 v[32:33], v62 offset:64000
    v_mfma_f32_32x32x16_bf16 v[208:223], v[12:15], v[24:27], v[208:223]
    ds_read_b64_tr_b16 v[34:35], v62 offset:64128
    ds_read_b64_tr_b16 v[36:37], v62 offset:64032
    ds_read_b64_tr_b16 v[38:39], v62 offset:64160
    v_mfma_f32_32x32x16_bf16 v[224:239], v[16:19], v[20:23], v[224:239]
    v_mfma_f32_32x32x16_bf16 v[240:255], v[16:19], v[24:27], v[240:255]
    s_waitcnt lgkmcnt(0)
    v_mfma_f32_32x32x16_bf16 v[192:207], v[32:35], v[40:43], v[192:207]
    ds_read_b128 v[20:23], v4 offset:16736
    ds_read_b128 v[24:27], v4 offset:16864
    ds_read_b64_tr_b16 v[12:13], v62 offset:64512
    v_mfma_f32_32x32x16_bf16 v[208:223], v[32:35], v[44:47], v[208:223]
    ds_read_b64_tr_b16 v[14:15], v62 offset:64640
    ds_read_b64_tr_b16 v[16:17], v62 offset:64544
    ds_read_b64_tr_b16 v[18:19], v62 offset:64672
    v_mfma_f32_32x32x16_bf16 v[224:239], v[36:39], v[40:43], v[224:239]
    v_mfma_f32_32x32x16_bf16 v[240:255], v[36:39], v[44:47], v[240:255]
    s_waitcnt lgkmcnt(0)
    s_barrier
    v_mfma_f32_32x32x16_bf16 v[192:207], v[12:15], v[20:23], v[192:207]
    v_mfma_f32_32x32x16_bf16 v[208:223], v[12:15], v[24:27], v[208:223]
    v_mfma_f32_32x32x16_bf16 v[224:239], v[16:19], v[20:23], v[224:239]
    v_mfma_f32_32x32x16_bf16 v[240:255], v[16:19], v[24:27], v[240:255]
    v_lshrrev_b32 v75, 1, v63
    v_sub_u32 v75, v77, v75
    ds_write2st64_b64 v75, v[144:145], v[146:147] offset0:0 offset1:1
    ds_write2st64_b64 v75, v[148:149], v[150:151] offset0:8 offset1:9
    ds_write2st64_b64 v75, v[176:177], v[178:179] offset0:16 offset1:17
    ds_write2st64_b64 v75, v[180:181], v[182:183] offset0:24 offset1:25
    s_branch LC_g4
L_end:
    s_endpgm
L_code_end:
.section .rodata,"a"
.p2align 6
.amdhsa_kernel recurrent_scan__mha_block__glu_gated_geglu__prompt_kernel
  .amdhsa_next_free_vgpr 256
  .amdhsa_next_free_sgpr 100
  .amdhsa_accum_offset 256
  .amdhsa_group_segment_fixed_size 0
  .amdhsa_kernarg_size 80
  .amdhsa_user_sgpr_count 2
  .amdhsa_user_sgpr_kernarg_segment_ptr 1
  .amdhsa_system_sgpr_workgroup_id_x 1
.end_amdhsa_kernel
```
